```python
import torch

def _softmax(x, axis=-1):
    return torch.softmax(x, dim=axis)
def _gelu(x):
    return torch.nn.functional.gelu(x, approximate="tanh")
def _silu(x):
    return torch.nn.functional.silu(x)
def _sigmoid(x):
    return torch.sigmoid(x)
def _layernorm(x, axis=-1, eps=1e-5):
    m = x.mean(dim=axis, keepdim=True)
    v = x.var(dim=axis, keepdim=True, unbiased=False)
    return (x - m) / torch.sqrt(v + eps)
def _scatter_add(tgt, idx, src, axis=0):
    return tgt.clone().index_add_(axis, idx, src)
def _segment_sum(src, seg, n):
    out = torch.zeros((n,) + src.shape[1:], dtype=src.dtype)
    return out.index_add_(0, seg, src)
def _pad(x, pw):
    flat = tuple(v for pair in reversed(pw) for v in pair)
    return torch.nn.functional.pad(x, flat)

kernel_name = 'gated_mix__ssm_conv_h3__dense_activation_mish__prompt'

def setup_inputs():

    _w = (lambda a: (lambda t: t.to(torch.bfloat16) if t.is_floating_point() else t)(torch.as_tensor(a)))
    def _A_setup():
        B, S, D = 1, 2048, 512
        ks = 4
        return {
            "q": _w((lambda *s: torch.randn(*s, dtype=torch.bfloat16) * 0.05)(B, S, D)),
            "k": _w((lambda *s: torch.randn(*s, dtype=torch.bfloat16) * 0.2)(B, S, D)),
            "v": _w((lambda *s: torch.randn(*s, dtype=torch.bfloat16) * 0.2)(B, S, D)),
            "shift_k": _w((lambda *s: torch.randn(*s, dtype=torch.bfloat16) * 0.2)(D, ks) * 0.5),
            "ssm_k": _w((lambda *s: torch.randn(*s, dtype=torch.bfloat16) * 0.8)(D, S) * (1.0 / S ** 0.5)),
            "ssm_D": _w((lambda *s: torch.randn(*s, dtype=torch.bfloat16) * 0.2)(D)),
        }
    _A_in = _A_setup()

    def _B_setup():
        B, S, D, F = 1, 2048, 512, 1376
        return {
            "x": _w((lambda *s: torch.randn(*s, dtype=torch.bfloat16) * 0.05)(B, S, D)),
            "w1": _w((lambda *s: torch.randn(*s, dtype=torch.bfloat16) * 3.2)(D, F) * (D ** -0.5)),
            "b1": _w((lambda *s: torch.randn(*s, dtype=torch.bfloat16) * 0.05)(F)),
            "w2": _w((lambda *s: torch.randn(*s, dtype=torch.bfloat16) * 0.05)(F, D) * (F ** -0.5)),
        }
    _B_in = _B_setup()

    return {
        "A_q": _A_in["q"],
        "A_k": _A_in["k"],
        "A_v": _A_in["v"],
        "A_shift_k": _A_in["shift_k"],
        "A_ssm_k": _A_in["ssm_k"],
        "A_ssm_D": _A_in["ssm_D"],
        "B_x": _B_in["x"],
        "B_w1": _B_in["w1"],
        "B_b1": _B_in["b1"],
        "B_w2": _B_in["w2"],
        "gate_w": _w((lambda *s: torch.randn(*s, dtype=torch.bfloat16) * 0.05)(512) * 16.0),
    }

def reference(A_q, A_k, A_v, A_shift_k, A_ssm_k, A_ssm_D, B_x, B_w1, B_b1, B_w2, gate_w):
    def _A_ref(q, k, v, shift_k, ssm_k, ssm_D):
        B, S, D = q.shape
        ks = shift_k.shape[-1]
        k_pad = _pad(k, ((0, 0), (ks - 1, 0), (0, 0)))
        k_shift = torch.zeros_like(k)
        for t in range(ks):
            k_shift = k_shift + k_pad[:, t:t + S, :] * shift_k[:, ks - 1 - t][None, None, :]
        kv = k_shift * v
        L = 2 * S
        kv_pad = _pad(kv, ((0, 0), (0, S), (0, 0)))
        kf_pad = _pad(ssm_k, ((0, 0), (0, S)))
        kv_f = (lambda x, axes=(-2,-1): torch.fft.rfft2(x.float(), dim=axes))(kv_pad[:, None, :, :], axes=(1, 2))
        kf_f = (lambda x, axes=(-2,-1): torch.fft.rfft2(x.float(), dim=axes))(kf_pad[:, None, :], axes=(1, 2))
        kf_f = (lambda x, *d: x.permute(*d))(kf_f, 1, 2, 0)
        y_f = kv_f * kf_f[None, :, :, :]
        y = (lambda x, s, axes=(-2,-1): torch.fft.irfft2(x, s=s, dim=axes).to(torch.bfloat16))(y_f, (1, L), axes=(1, 2))[:, 0, :S, :]
        y = y + kv * ssm_D[None, None, :]
        return q * y

    def _B_ref(x, w1, b1, w2):
        h = torch.einsum("bsd,df->bsf", x, w1) + b1
        sp = torch.log1p(torch.exp(-torch.abs(h))) + torch.where(h > 0, h, torch.zeros_like(h))
        act = h * torch.tanh(sp)
        return torch.einsum("bsf,fd->bsd", act, w2)

    x = A_q
    g = _sigmoid((x * gate_w).sum(-1, keepdims=True))
    a = _A_ref(x, A_k, A_v, A_shift_k, A_ssm_k, A_ssm_D)
    b = _B_ref(x, B_w1, B_b1, B_w2)
    return g * a + (1 - g) * b
```

```asm
; @launch kernel=conv_gemm1_kernel grid=(256,1,1) block=(512,1,1) lds=141312
; @launch kernel=gemm2_kernel grid=(256,1,1) block=(256,1,1) lds=55296
.amdgcn_target "amdgcn-amd-amdhsa--gfx950"
.text
.globl conv_gemm1_kernel
.p2align 8
.type conv_gemm1_kernel,@function
conv_gemm1_kernel:
    v_readfirstlane_b32 s3, v0
    s_lshr_b32 s3, s3, 6
    v_and_b32 v1, 63, v0
    s_load_dwordx2 s[4:5], s[0:1], 104
    s_cmp_ge_u32 s2, 256
    s_cbranch_scc1 L_k1_done
    s_cmp_ge_u32 s2, 128
    s_cbranch_scc1 L_k1_gemm1
    s_load_dwordx2 s[6:7], s[0:1], 32
    s_load_dwordx2 s[8:9], s[0:1], 40
    s_load_dwordx2 s[10:11], s[0:1], 8
    s_load_dwordx2 s[12:13], s[0:1], 16
    s_load_dwordx2 s[14:15], s[0:1], 24
    s_and_b32 s16, s2, 7
    s_lshl_b32 s16, s16, 4
    s_lshr_b32 s17, s2, 3
    s_add_u32 s16, s16, s17
    s_lshl_b32 s17, s16, 2
    s_and_b32 s18, s3, 3
    s_add_u32 s20, s17, s18
    s_mul_i32 s21, s18, 25088
    v_and_b32 v2, 31, v1
    v_lshrrev_b32 v3, 5, v1
    v_lshlrev_b32 v4, 4, v1
    s_waitcnt lgkmcnt(0)
    s_mov_b32 s28, s6
    s_mov_b32 s29, s7
    s_mov_b32 s30, 0x200000
    s_mov_b32 s31, 0x00020000
    s_mov_b32 s32, s8
    s_mov_b32 s33, s9
    s_mov_b32 s34, 0x400
    s_mov_b32 s35, 0x00020000
    s_mov_b32 s36, s10
    s_mov_b32 s37, s11
    s_mov_b32 s38, 0x200000
    s_mov_b32 s39, 0x00020000
    s_mov_b32 s44, s12
    s_mov_b32 s45, s13
    s_mov_b32 s46, 0x200000
    s_mov_b32 s47, 0x00020000
    s_mov_b32 s48, s14
    s_mov_b32 s49, s15
    s_mov_b32 s50, 0x1000
    s_mov_b32 s51, 0x00020000
    s_mov_b32 s40, s4
    s_mov_b32 s41, s5
    s_mov_b32 s42, 0x10000000
    s_mov_b32 s43, 0x00020000
    s_lshl_b32 s22, s20, 12
    v_add_u32 v6, s22, v4
    s_cmp_ge_u32 s3, 4
    s_cbranch_scc1 L_cv_nohload
    buffer_load_dwordx4 v[96:99], v6, s[28:31], 0 offen offset:0
    buffer_load_dwordx4 v[100:103], v6, s[28:31], 0 offen offset:4
    buffer_load_dwordx4 v[104:107], v6, s[28:31], 0 offen offset:8
    buffer_load_dwordx4 v[108:111], v6, s[28:31], 0 offen offset:1024
    buffer_load_dwordx4 v[112:115], v6, s[28:31], 0 offen offset:1028
    buffer_load_dwordx4 v[116:119], v6, s[28:31], 0 offen offset:1032
    buffer_load_dwordx4 v[120:123], v6, s[28:31], 0 offen offset:2048
    buffer_load_dwordx4 v[124:127], v6, s[28:31], 0 offen offset:2052
    buffer_load_dwordx4 v[128:131], v6, s[28:31], 0 offen offset:2056
    buffer_load_dwordx4 v[132:135], v6, s[28:31], 0 offen offset:3072
    buffer_load_dwordx4 v[136:139], v6, s[28:31], 0 offen offset:3076
    buffer_load_dwordx4 v[140:143], v6, s[28:31], 0 offen offset:3080
    s_lshl_b32 s24, s20, 1
    v_mov_b32 v8, s24
    buffer_load_ushort v9, v8, s[32:35], 0 offen
L_cv_nohload:
    v_lshlrev_b32 v10, 2, v0
    v_subrev_u32 v10, 3, v10
    v_lshlrev_b32 v10, 10, v10
    s_lshl_b32 s19, s17, 1
    v_add_u32 v10, s19, v10
    v_add_u32 v11, 1024, v10
    v_add_u32 v12, 2048, v10
    v_add_u32 v13, 3072, v10
    v_add_u32 v14, 4096, v10
    v_add_u32 v15, 5120, v10
    v_add_u32 v16, 6144, v10
    buffer_load_dwordx2 v[20:21], v10, s[36:39], 0 offen
    buffer_load_dwordx2 v[22:23], v11, s[36:39], 0 offen
    buffer_load_dwordx2 v[24:25], v12, s[36:39], 0 offen
    buffer_load_dwordx2 v[26:27], v13, s[36:39], 0 offen
    buffer_load_dwordx2 v[28:29], v14, s[36:39], 0 offen
    buffer_load_dwordx2 v[30:31], v15, s[36:39], 0 offen
    buffer_load_dwordx2 v[32:33], v16, s[36:39], 0 offen
    buffer_load_dwordx2 v[34:35], v13, s[44:47], 0 offen offset:0
    buffer_load_dwordx2 v[36:37], v13, s[44:47], 0 offen offset:1024
    buffer_load_dwordx2 v[38:39], v13, s[44:47], 0 offen offset:2048
    buffer_load_dwordx2 v[40:41], v13, s[44:47], 0 offen offset:3072
    s_lshl_b32 s19, s17, 3
    v_mov_b32 v17, s19
    buffer_load_dwordx4 v[42:45], v17, s[48:51], 0 offen
    buffer_load_dwordx4 v[46:49], v17, s[48:51], 0 offen offset:16
    v_lshrrev_b32 v18, 3, v0
    v_mul_u32_u24 v18, 80, v18
    v_and_b32 v19, 7, v0
    v_lshlrev_b32 v19, 3, v19
    v_sub_u32 v18, v18, v19
    v_add_u32 v18, 19944, v18
    s_cmp_ge_u32 s3, 4
    s_cbranch_scc1 L_cv_nozero
    v_mov_b32 v200, 0
    v_mov_b32 v201, 0
    v_mov_b32 v202, 0
    v_mov_b32 v203, 0
    v_add_u32 v5, s21, v4
    ds_write_b128 v5, v[200:203] offset:17408
    ds_write_b128 v5, v[200:203] offset:18432
    v_cmp_gt_u32 vcc, 27, v1
    s_and_saveexec_b64 s[54:55], vcc
    ds_write_b128 v5, v[200:203] offset:19456
    s_mov_b64 exec, s[54:55]
L_cv_nozero:
    s_waitcnt vmcnt(0)
    v_lshlrev_b32 v152, 16, v20
    v_and_b32 v153, 0xffff0000, v20
    v_lshlrev_b32 v154, 16, v22
    v_and_b32 v155, 0xffff0000, v22
    v_lshlrev_b32 v156, 16, v24
    v_and_b32 v157, 0xffff0000, v24
    v_lshlrev_b32 v158, 16, v26
    v_and_b32 v159, 0xffff0000, v26
    v_lshlrev_b32 v160, 16, v28
    v_and_b32 v161, 0xffff0000, v28
    v_lshlrev_b32 v162, 16, v30
    v_and_b32 v163, 0xffff0000, v30
    v_lshlrev_b32 v164, 16, v32
    v_and_b32 v165, 0xffff0000, v32
    v_lshlrev_b32 v166, 16, v34
    v_and_b32 v167, 0xffff0000, v34
    v_lshlrev_b32 v168, 16, v36
    v_and_b32 v169, 0xffff0000, v36
    v_lshlrev_b32 v170, 16, v38
    v_and_b32 v171, 0xffff0000, v38
    v_lshlrev_b32 v172, 16, v40
    v_and_b32 v173, 0xffff0000, v40
    v_lshlrev_b32 v174, 16, v42
    v_lshlrev_b32 v175, 16, v44
    v_and_b32 v176, 0xffff0000, v42
    v_and_b32 v177, 0xffff0000, v44
    v_lshlrev_b32 v178, 16, v43
    v_lshlrev_b32 v179, 16, v45
    v_and_b32 v180, 0xffff0000, v43
    v_and_b32 v181, 0xffff0000, v45
    v_pk_mul_f32 v[182:183], v[152:153], v[180:181]
    v_cvt_pk_bf16_f32 v186, v182, v183
    v_lshlrev_b32 v184, 16, v186
    v_and_b32 v185, 0xffff0000, v186
    v_pk_mul_f32 v[182:183], v[154:155], v[178:179]
    v_cvt_pk_bf16_f32 v186, v182, v183
    v_lshlrev_b32 v182, 16, v186
    v_and_b32 v183, 0xffff0000, v186
    v_pk_add_f32 v[184:185], v[184:185], v[182:183]
    v_cvt_pk_bf16_f32 v186, v184, v185
    v_lshlrev_b32 v184, 16, v186
    v_and_b32 v185, 0xffff0000, v186
    v_pk_mul_f32 v[182:183], v[156:157], v[176:177]
    v_cvt_pk_bf16_f32 v186, v182, v183
    v_lshlrev_b32 v182, 16, v186
    v_and_b32 v183, 0xffff0000, v186
    v_pk_add_f32 v[184:185], v[184:185], v[182:183]
    v_cvt_pk_bf16_f32 v186, v184, v185
    v_lshlrev_b32 v184, 16, v186
    v_and_b32 v185, 0xffff0000, v186
    v_pk_mul_f32 v[182:183], v[158:159], v[174:175]
    v_cvt_pk_bf16_f32 v186, v182, v183
    v_lshlrev_b32 v182, 16, v186
    v_and_b32 v183, 0xffff0000, v186
    v_pk_add_f32 v[184:185], v[184:185], v[182:183]
    v_cvt_pk_bf16_f32 v186, v184, v185
    v_lshlrev_b32 v184, 16, v186
    v_and_b32 v185, 0xffff0000, v186
    v_pk_mul_f32 v[188:189], v[184:185], v[166:167]
    v_pk_mul_f32 v[182:183], v[154:155], v[180:181]
    v_cvt_pk_bf16_f32 v186, v182, v183
    v_lshlrev_b32 v184, 16, v186
    v_and_b32 v185, 0xffff0000, v186
    v_pk_mul_f32 v[182:183], v[156:157], v[178:179]
    v_cvt_pk_bf16_f32 v186, v182, v183
    v_lshlrev_b32 v182, 16, v186
    v_and_b32 v183, 0xffff0000, v186
    v_pk_add_f32 v[184:185], v[184:185], v[182:183]
    v_cvt_pk_bf16_f32 v186, v184, v185
    v_lshlrev_b32 v184, 16, v186
    v_and_b32 v185, 0xffff0000, v186
    v_pk_mul_f32 v[182:183], v[158:159], v[176:177]
    v_cvt_pk_bf16_f32 v186, v182, v183
    v_lshlrev_b32 v182, 16, v186
    v_and_b32 v183, 0xffff0000, v186
    v_pk_add_f32 v[184:185], v[184:185], v[182:183]
    v_cvt_pk_bf16_f32 v186, v184, v185
    v_lshlrev_b32 v184, 16, v186
    v_and_b32 v185, 0xffff0000, v186
    v_pk_mul_f32 v[182:183], v[160:161], v[174:175]
    v_cvt_pk_bf16_f32 v186, v182, v183
    v_lshlrev_b32 v182, 16, v186
    v_and_b32 v183, 0xffff0000, v186
    v_pk_add_f32 v[184:185], v[184:185], v[182:183]
    v_cvt_pk_bf16_f32 v186, v184, v185
    v_lshlrev_b32 v184, 16, v186
    v_and_b32 v185, 0xffff0000, v186
    v_pk_mul_f32 v[190:191], v[184:185], v[168:169]
    v_pk_mul_f32 v[182:183], v[156:157], v[180:181]
    v_cvt_pk_bf16_f32 v186, v182, v183
    v_lshlrev_b32 v184, 16, v186
    v_and_b32 v185, 0xffff0000, v186
    v_pk_mul_f32 v[182:183], v[158:159], v[178:179]
    v_cvt_pk_bf16_f32 v186, v182, v183
    v_lshlrev_b32 v182, 16, v186
    v_and_b32 v183, 0xffff0000, v186
    v_pk_add_f32 v[184:185], v[184:185], v[182:183]
    v_cvt_pk_bf16_f32 v186, v184, v185
    v_lshlrev_b32 v184, 16, v186
    v_and_b32 v185, 0xffff0000, v186
    v_pk_mul_f32 v[182:183], v[160:161], v[176:177]
    v_cvt_pk_bf16_f32 v186, v182, v183
    v_lshlrev_b32 v182, 16, v186
    v_and_b32 v183, 0xffff0000, v186
    v_pk_add_f32 v[184:185], v[184:185], v[182:183]
    v_cvt_pk_bf16_f32 v186, v184, v185
    v_lshlrev_b32 v184, 16, v186
    v_and_b32 v185, 0xffff0000, v186
    v_pk_mul_f32 v[182:183], v[162:163], v[174:175]
    v_cvt_pk_bf16_f32 v186, v182, v183
    v_lshlrev_b32 v182, 16, v186
    v_and_b32 v183, 0xffff0000, v186
    v_pk_add_f32 v[184:185], v[184:185], v[182:183]
    v_cvt_pk_bf16_f32 v186, v184, v185
    v_lshlrev_b32 v184, 16, v186
    v_and_b32 v185, 0xffff0000, v186
    v_pk_mul_f32 v[192:193], v[184:185], v[170:171]
    v_pk_mul_f32 v[182:183], v[158:159], v[180:181]
    v_cvt_pk_bf16_f32 v186, v182, v183
    v_lshlrev_b32 v184, 16, v186
    v_and_b32 v185, 0xffff0000, v186
    v_pk_mul_f32 v[182:183], v[160:161], v[178:179]
    v_cvt_pk_bf16_f32 v186, v182, v183
    v_lshlrev_b32 v182, 16, v186
    v_and_b32 v183, 0xffff0000, v186
    v_pk_add_f32 v[184:185], v[184:185], v[182:183]
    v_cvt_pk_bf16_f32 v186, v184, v185
    v_lshlrev_b32 v184, 16, v186
    v_and_b32 v185, 0xffff0000, v186
    v_pk_mul_f32 v[182:183], v[162:163], v[176:177]
    v_cvt_pk_bf16_f32 v186, v182, v183
    v_lshlrev_b32 v182, 16, v186
    v_and_b32 v183, 0xffff0000, v186
    v_pk_add_f32 v[184:185], v[184:185], v[182:183]
    v_cvt_pk_bf16_f32 v186, v184, v185
    v_lshlrev_b32 v184, 16, v186
    v_and_b32 v185, 0xffff0000, v186
    v_pk_mul_f32 v[182:183], v[164:165], v[174:175]
    v_cvt_pk_bf16_f32 v186, v182, v183
    v_lshlrev_b32 v182, 16, v186
    v_and_b32 v183, 0xffff0000, v186
    v_pk_add_f32 v[184:185], v[184:185], v[182:183]
    v_cvt_pk_bf16_f32 v186, v184, v185
    v_lshlrev_b32 v184, 16, v186
    v_and_b32 v185, 0xffff0000, v186
    v_pk_mul_f32 v[194:195], v[184:185], v[172:173]
    v_cvt_pk_bf16_f32 v196, v194, v192
    v_cvt_pk_bf16_f32 v197, v190, v188
    v_add_u32 v19, 0, v18
    ds_write_b64 v19, v[196:197]
    s_nop 0
    v_cvt_pk_bf16_f32 v196, v195, v193
    v_cvt_pk_bf16_f32 v197, v191, v189
    v_add_u32 v19, 25088, v18
    ds_write_b64 v19, v[196:197]
    s_nop 0
    v_lshlrev_b32 v152, 16, v21
    v_and_b32 v153, 0xffff0000, v21
    v_lshlrev_b32 v154, 16, v23
    v_and_b32 v155, 0xffff0000, v23
    v_lshlrev_b32 v156, 16, v25
    v_and_b32 v157, 0xffff0000, v25
    v_lshlrev_b32 v158, 16, v27
    v_and_b32 v159, 0xffff0000, v27
    v_lshlrev_b32 v160, 16, v29
    v_and_b32 v161, 0xffff0000, v29
    v_lshlrev_b32 v162, 16, v31
    v_and_b32 v163, 0xffff0000, v31
    v_lshlrev_b32 v164, 16, v33
    v_and_b32 v165, 0xffff0000, v33
    v_lshlrev_b32 v166, 16, v35
    v_and_b32 v167, 0xffff0000, v35
    v_lshlrev_b32 v168, 16, v37
    v_and_b32 v169, 0xffff0000, v37
    v_lshlrev_b32 v170, 16, v39
    v_and_b32 v171, 0xffff0000, v39
    v_lshlrev_b32 v172, 16, v41
    v_and_b32 v173, 0xffff0000, v41
    v_lshlrev_b32 v174, 16, v46
    v_lshlrev_b32 v175, 16, v48
    v_and_b32 v176, 0xffff0000, v46
    v_and_b32 v177, 0xffff0000, v48
    v_lshlrev_b32 v178, 16, v47
    v_lshlrev_b32 v179, 16, v49
    v_and_b32 v180, 0xffff0000, v47
    v_and_b32 v181, 0xffff0000, v49
    v_pk_mul_f32 v[182:183], v[152:153], v[180:181]
    v_cvt_pk_bf16_f32 v186, v182, v183
    v_lshlrev_b32 v184, 16, v186
    v_and_b32 v185, 0xffff0000, v186
    v_pk_mul_f32 v[182:183], v[154:155], v[178:179]
    v_cvt_pk_bf16_f32 v186, v182, v183
    v_lshlrev_b32 v182, 16, v186
    v_and_b32 v183, 0xffff0000, v186
    v_pk_add_f32 v[184:185], v[184:185], v[182:183]
    v_cvt_pk_bf16_f32 v186, v184, v185
    v_lshlrev_b32 v184, 16, v186
    v_and_b32 v185, 0xffff0000, v186
    v_pk_mul_f32 v[182:183], v[156:157], v[176:177]
    v_cvt_pk_bf16_f32 v186, v182, v183
    v_lshlrev_b32 v182, 16, v186
    v_and_b32 v183, 0xffff0000, v186
    v_pk_add_f32 v[184:185], v[184:185], v[182:183]
    v_cvt_pk_bf16_f32 v186, v184, v185
    v_lshlrev_b32 v184, 16, v186
    v_and_b32 v185, 0xffff0000, v186
    v_pk_mul_f32 v[182:183], v[158:159], v[174:175]
    v_cvt_pk_bf16_f32 v186, v182, v183
    v_lshlrev_b32 v182, 16, v186
    v_and_b32 v183, 0xffff0000, v186
    v_pk_add_f32 v[184:185], v[184:185], v[182:183]
    v_cvt_pk_bf16_f32 v186, v184, v185
    v_lshlrev_b32 v184, 16, v186
    v_and_b32 v185, 0xffff0000, v186
    v_pk_mul_f32 v[188:189], v[184:185], v[166:167]
    v_pk_mul_f32 v[182:183], v[154:155], v[180:181]
    v_cvt_pk_bf16_f32 v186, v182, v183
    v_lshlrev_b32 v184, 16, v186
    v_and_b32 v185, 0xffff0000, v186
    v_pk_mul_f32 v[182:183], v[156:157], v[178:179]
    v_cvt_pk_bf16_f32 v186, v182, v183
    v_lshlrev_b32 v182, 16, v186
    v_and_b32 v183, 0xffff0000, v186
    v_pk_add_f32 v[184:185], v[184:185], v[182:183]
    v_cvt_pk_bf16_f32 v186, v184, v185
    v_lshlrev_b32 v184, 16, v186
    v_and_b32 v185, 0xffff0000, v186
    v_pk_mul_f32 v[182:183], v[158:159], v[176:177]
    v_cvt_pk_bf16_f32 v186, v182, v183
    v_lshlrev_b32 v182, 16, v186
    v_and_b32 v183, 0xffff0000, v186
    v_pk_add_f32 v[184:185], v[184:185], v[182:183]
    v_cvt_pk_bf16_f32 v186, v184, v185
    v_lshlrev_b32 v184, 16, v186
    v_and_b32 v185, 0xffff0000, v186
    v_pk_mul_f32 v[182:183], v[160:161], v[174:175]
    v_cvt_pk_bf16_f32 v186, v182, v183
    v_lshlrev_b32 v182, 16, v186
    v_and_b32 v183, 0xffff0000, v186
    v_pk_add_f32 v[184:185], v[184:185], v[182:183]
    v_cvt_pk_bf16_f32 v186, v184, v185
    v_lshlrev_b32 v184, 16, v186
    v_and_b32 v185, 0xffff0000, v186
    v_pk_mul_f32 v[190:191], v[184:185], v[168:169]
    v_pk_mul_f32 v[182:183], v[156:157], v[180:181]
    v_cvt_pk_bf16_f32 v186, v182, v183
    v_lshlrev_b32 v184, 16, v186
    v_and_b32 v185, 0xffff0000, v186
    v_pk_mul_f32 v[182:183], v[158:159], v[178:179]
    v_cvt_pk_bf16_f32 v186, v182, v183
    v_lshlrev_b32 v182, 16, v186
    v_and_b32 v183, 0xffff0000, v186
    v_pk_add_f32 v[184:185], v[184:185], v[182:183]
    v_cvt_pk_bf16_f32 v186, v184, v185
    v_lshlrev_b32 v184, 16, v186
    v_and_b32 v185, 0xffff0000, v186
    v_pk_mul_f32 v[182:183], v[160:161], v[176:177]
    v_cvt_pk_bf16_f32 v186, v182, v183
    v_lshlrev_b32 v182, 16, v186
    v_and_b32 v183, 0xffff0000, v186
    v_pk_add_f32 v[184:185], v[184:185], v[182:183]
    v_cvt_pk_bf16_f32 v186, v184, v185
    v_lshlrev_b32 v184, 16, v186
    v_and_b32 v185, 0xffff0000, v186
    v_pk_mul_f32 v[182:183], v[162:163], v[174:175]
    v_cvt_pk_bf16_f32 v186, v182, v183
    v_lshlrev_b32 v182, 16, v186
    v_and_b32 v183, 0xffff0000, v186
    v_pk_add_f32 v[184:185], v[184:185], v[182:183]
    v_cvt_pk_bf16_f32 v186, v184, v185
    v_lshlrev_b32 v184, 16, v186
    v_and_b32 v185, 0xffff0000, v186
    v_pk_mul_f32 v[192:193], v[184:185], v[170:171]
    v_pk_mul_f32 v[182:183], v[158:159], v[180:181]
    v_cvt_pk_bf16_f32 v186, v182, v183
    v_lshlrev_b32 v184, 16, v186
    v_and_b32 v185, 0xffff0000, v186
    v_pk_mul_f32 v[182:183], v[160:161], v[178:179]
    v_cvt_pk_bf16_f32 v186, v182, v183
    v_lshlrev_b32 v182, 16, v186
    v_and_b32 v183, 0xffff0000, v186
    v_pk_add_f32 v[184:185], v[184:185], v[182:183]
    v_cvt_pk_bf16_f32 v186, v184, v185
    v_lshlrev_b32 v184, 16, v186
    v_and_b32 v185, 0xffff0000, v186
    v_pk_mul_f32 v[182:183], v[162:163], v[176:177]
    v_cvt_pk_bf16_f32 v186, v182, v183
    v_lshlrev_b32 v182, 16, v186
    v_and_b32 v183, 0xffff0000, v186
    v_pk_add_f32 v[184:185], v[184:185], v[182:183]
    v_cvt_pk_bf16_f32 v186, v184, v185
    v_lshlrev_b32 v184, 16, v186
    v_and_b32 v185, 0xffff0000, v186
    v_pk_mul_f32 v[182:183], v[164:165], v[174:175]
    v_cvt_pk_bf16_f32 v186, v182, v183
    v_lshlrev_b32 v182, 16, v186
    v_and_b32 v183, 0xffff0000, v186
    v_pk_add_f32 v[184:185], v[184:185], v[182:183]
    v_cvt_pk_bf16_f32 v186, v184, v185
    v_lshlrev_b32 v184, 16, v186
    v_and_b32 v185, 0xffff0000, v186
    v_pk_mul_f32 v[194:195], v[184:185], v[172:173]
    v_cvt_pk_bf16_f32 v196, v194, v192
    v_cvt_pk_bf16_f32 v197, v190, v188
    v_add_u32 v19, 50176, v18
    ds_write_b64 v19, v[196:197]
    s_nop 0
    v_cvt_pk_bf16_f32 v196, v195, v193
    v_cvt_pk_bf16_f32 v197, v191, v189
    v_add_u32 v19, 75264, v18
    ds_write_b64 v19, v[196:197]
    s_nop 0
    s_cmp_ge_u32 s3, 4
    s_cbranch_scc1 L_cv_aux
    v_add_u32 v10, 1, v2
    v_and_b32 v11, 3, v10
    v_mov_b32 v12, 13240
    v_cmp_eq_u32 vcc, 1, v11
    v_mov_b32 v13, 0
    s_nop 1
    v_cndmask_b32 v12, v12, v13, vcc
    v_cmp_eq_u32 vcc, 2, v11
    v_mov_b32 v13, 4416
    s_nop 1
    v_cndmask_b32 v12, v12, v13, vcc
    v_cmp_eq_u32 vcc, 3, v11
    v_mov_b32 v13, 8832
    s_nop 1
    v_cndmask_b32 v12, v12, v13, vcc
    v_lshlrev_b32 v13, 3, v3
    v_add_u32 v13, v13, v10
    v_sub_u32 v13, v13, v11
    v_lshlrev_b32 v13, 1, v13
    v_add3_u32 v20, v12, v13, s21
    v_mul_u32_u24 v13, 80, v2
    v_lshlrev_b32 v14, 4, v3
    v_add3_u32 v21, v13, v14, s21
    v_add_u32 v21, 17408, v21
    v_lshlrev_b32 v14, 3, v3
    v_sub_u32 v22, v13, v14
    v_add_u32 v22, 19896, v22
    v_add_u32 v22, s21, v22
    s_add_u32 s25, s22, 2097152
    v_lshlrev_b32 v13, 6, v2
    v_lshlrev_b32 v14, 3, v3
    v_add3_u32 v23, v13, v14, s25
    v_lshlrev_b32 v13, 3, v3
    v_add_u32 v13, v13, v2
    v_sub_u32 v13, 15, v13
    v_cmp_le_i32 vcc, v13, 0
    v_mov_b32 v14, 0xffff
    s_nop 1
    v_cndmask_b32 v152, 0, v14, vcc
    v_cmp_le_i32 vcc, v13, 1
    v_mov_b32 v14, 0xffff0000
    s_nop 1
    v_cndmask_b32 v15, 0, v14, vcc
    v_or_b32 v152, v152, v15
    v_cmp_le_i32 vcc, v13, 2
    v_mov_b32 v14, 0xffff
    s_nop 1
    v_cndmask_b32 v153, 0, v14, vcc
    v_cmp_le_i32 vcc, v13, 3
    v_mov_b32 v14, 0xffff0000
    s_nop 1
    v_cndmask_b32 v15, 0, v14, vcc
    v_or_b32 v153, v153, v15
    v_cmp_le_i32 vcc, v13, 4
    v_mov_b32 v14, 0xffff
    s_nop 1
    v_cndmask_b32 v154, 0, v14, vcc
    v_cmp_le_i32 vcc, v13, 5
    v_mov_b32 v14, 0xffff0000
    s_nop 1
    v_cndmask_b32 v15, 0, v14, vcc
    v_or_b32 v154, v154, v15
    v_cmp_le_i32 vcc, v13, 6
    v_mov_b32 v14, 0xffff
    s_nop 1
    v_cndmask_b32 v155, 0, v14, vcc
    v_cmp_le_i32 vcc, v13, 7
    v_mov_b32 v14, 0xffff0000
    s_nop 1
    v_cndmask_b32 v15, 0, v14, vcc
    v_or_b32 v155, v155, v15
    v_lshlrev_b32 v13, 3, v3
    v_add_u32 v13, v13, v2
    v_sub_u32 v13, 31, v13
    v_cmp_le_i32 vcc, v13, 0
    v_mov_b32 v14, 0xffff
    s_nop 1
    v_cndmask_b32 v156, 0, v14, vcc
    v_cmp_le_i32 vcc, v13, 1
    v_mov_b32 v14, 0xffff0000
    s_nop 1
    v_cndmask_b32 v15, 0, v14, vcc
    v_or_b32 v156, v156, v15
    v_cmp_le_i32 vcc, v13, 2
    v_mov_b32 v14, 0xffff
    s_nop 1
    v_cndmask_b32 v157, 0, v14, vcc
    v_cmp_le_i32 vcc, v13, 3
    v_mov_b32 v14, 0xffff0000
    s_nop 1
    v_cndmask_b32 v15, 0, v14, vcc
    v_or_b32 v157, v157, v15
    v_cmp_le_i32 vcc, v13, 4
    v_mov_b32 v14, 0xffff
    s_nop 1
    v_cndmask_b32 v158, 0, v14, vcc
    v_cmp_le_i32 vcc, v13, 5
    v_mov_b32 v14, 0xffff0000
    s_nop 1
    v_cndmask_b32 v15, 0, v14, vcc
    v_or_b32 v158, v158, v15
    v_cmp_le_i32 vcc, v13, 6
    v_mov_b32 v14, 0xffff
    s_nop 1
    v_cndmask_b32 v159, 0, v14, vcc
    v_cmp_le_i32 vcc, v13, 7
    v_mov_b32 v14, 0xffff0000
    s_nop 1
    v_cndmask_b32 v15, 0, v14, vcc
    v_or_b32 v159, v159, v15
    ds_write_b128 v5, v[96:99] offset:13304
    ds_write_b128 v5, v[100:103] offset:4480
    v_alignbit_b32 v144, v97, v96, 16
    v_alignbit_b32 v145, v98, v97, 16
    v_alignbit_b32 v146, v99, v98, 16
    v_alignbit_b32 v147, v103, v99, 16
    v_alignbit_b32 v148, v101, v100, 16
    v_alignbit_b32 v149, v102, v101, 16
    v_alignbit_b32 v150, v103, v102, 16
    v_alignbit_b32 v151, v107, v103, 16
    ds_write_b128 v5, v[144:147] offset:64
    ds_write_b128 v5, v[148:151] offset:8896
    s_nop 1
    ds_write_b128 v5, v[108:111] offset:14328
    ds_write_b128 v5, v[112:115] offset:5504
    v_alignbit_b32 v144, v109, v108, 16
    v_alignbit_b32 v145, v110, v109, 16
    v_alignbit_b32 v146, v111, v110, 16
    v_alignbit_b32 v147, v115, v111, 16
    v_alignbit_b32 v148, v113, v112, 16
    v_alignbit_b32 v149, v114, v113, 16
    v_alignbit_b32 v150, v115, v114, 16
    v_alignbit_b32 v151, v119, v115, 16
    ds_write_b128 v5, v[144:147] offset:1088
    ds_write_b128 v5, v[148:151] offset:9920
    s_nop 1
    ds_write_b128 v5, v[120:123] offset:15352
    ds_write_b128 v5, v[124:127] offset:6528
    v_alignbit_b32 v144, v121, v120, 16
    v_alignbit_b32 v145, v122, v121, 16
    v_alignbit_b32 v146, v123, v122, 16
    v_alignbit_b32 v147, v127, v123, 16
    v_alignbit_b32 v148, v125, v124, 16
    v_alignbit_b32 v149, v126, v125, 16
    v_alignbit_b32 v150, v127, v126, 16
    v_alignbit_b32 v151, v131, v127, 16
    ds_write_b128 v5, v[144:147] offset:2112
    ds_write_b128 v5, v[148:151] offset:10944
    s_nop 1
    ds_write_b128 v5, v[132:135] offset:16376
    ds_write_b128 v5, v[136:139] offset:7552
    v_alignbit_b32 v144, v133, v132, 16
    v_alignbit_b32 v145, v134, v133, 16
    v_alignbit_b32 v146, v135, v134, 16
    v_alignbit_b32 v147, v139, v135, 16
    v_alignbit_b32 v148, v137, v136, 16
    v_alignbit_b32 v149, v138, v137, 16
    v_alignbit_b32 v150, v139, v138, 16
    v_alignbit_b32 v151, v143, v139, 16
    ds_write_b128 v5, v[144:147] offset:3136
    ds_write_b128 v5, v[148:151] offset:11968
    s_nop 1
    v_cmp_le_u32 vcc, 1, v1
    v_cndmask_b32 v13, 1, 2, vcc
    v_cmp_le_u32 vcc, 3, v1
    s_nop 1
    v_cndmask_b32 v13, v13, 3, vcc
    v_cmp_eq_u32 vcc, 2, v13
    v_cndmask_b32 v14, 0, 1, vcc
    v_cmp_eq_u32 vcc, 3, v13
    s_nop 1
    v_cndmask_b32 v14, v14, 3, vcc
    v_sub_u32 v14, v1, v14
    v_lshlrev_b32 v15, 1, v14
    v_add_u32 v16, s22, v15
    v_mov_b32 v17, 0
    v_cmp_eq_u32 vcc, 2, v13
    v_mov_b32 v18, 4416
    s_nop 1
    v_cndmask_b32 v17, v17, v18, vcc
    v_cmp_eq_u32 vcc, 3, v13
    v_mov_b32 v18, 8832
    s_nop 1
    v_cndmask_b32 v17, v17, v18, vcc
    v_sub_u32 v18, 32, v13
    v_add_u32 v18, v18, v14
    v_lshlrev_b32 v18, 1, v18
    v_add3_u32 v17, v17, v18, s21
    v_cmp_gt_u32 vcc, 6, v1
    s_and_saveexec_b64 s[54:55], vcc
    buffer_load_ushort v19, v16, s[28:31], 0 offen
    s_waitcnt vmcnt(0)
    ds_write_b16 v17, v19
    s_mov_b64 exec, s[54:55]
    v_lshlrev_b32 v9, 16, v9
    s_waitcnt vmcnt(0) lgkmcnt(0)
    s_barrier
    v_mov_b32 v32, 0
    v_mov_b32 v33, 0
    v_mov_b32 v34, 0
    v_mov_b32 v35, 0
    v_mov_b32 v36, 0
    v_mov_b32 v37, 0
    v_mov_b32 v38, 0
    v_mov_b32 v39, 0
    v_mov_b32 v40, 0
    v_mov_b32 v41, 0
    v_mov_b32 v42, 0
    v_mov_b32 v43, 0
    v_mov_b32 v44, 0
    v_mov_b32 v45, 0
    v_mov_b32 v46, 0
    v_mov_b32 v47, 0
    v_mov_b32 v48, 0
    v_mov_b32 v49, 0
    v_mov_b32 v50, 0
    v_mov_b32 v51, 0
    v_mov_b32 v52, 0
    v_mov_b32 v53, 0
    v_mov_b32 v54, 0
    v_mov_b32 v55, 0
    v_mov_b32 v56, 0
    v_mov_b32 v57, 0
    v_mov_b32 v58, 0
    v_mov_b32 v59, 0
    v_mov_b32 v60, 0
    v_mov_b32 v61, 0
    v_mov_b32 v62, 0
    v_mov_b32 v63, 0
    ds_read_b64 v[64:65], v20 offset:32
    ds_read_b64 v[66:67], v20 offset:40
    ds_read_b64 v[68:69], v20 offset:2080
    ds_read_b64 v[70:71], v20 offset:2088
    ds_read_b128 v[76:79], v21 offset:2512
    ds_read_b128 v[72:75], v21 offset:5072
    ds_read_b64 v[80:81], v20 offset:0
    ds_read_b64 v[82:83], v20 offset:8
    ds_read_b64 v[84:85], v20 offset:2048
    ds_read_b64 v[86:87], v20 offset:2056
    ds_read_b128 v[92:95], v21 offset:2480
    ds_read_b128 v[88:91], v21 offset:5040
    s_waitcnt lgkmcnt(6)
    v_and_b32 v64, v64, v152
    v_and_b32 v65, v65, v153
    v_and_b32 v66, v66, v154
    v_and_b32 v67, v67, v155
    s_nop 1
    v_mfma_f32_32x32x16_bf16 v[48:63], v[64:67], v[72:75], v[48:63]
    v_mfma_f32_32x32x16_bf16 v[32:47], v[64:67], v[76:79], v[32:47]
    v_mfma_f32_32x32x16_bf16 v[48:63], v[68:71], v[76:79], v[48:63]
    ds_read_b64 v[64:65], v20 offset:96
    ds_read_b64 v[66:67], v20 offset:104
    ds_read_b64 v[68:69], v20 offset:2144
    ds_read_b64 v[70:71], v20 offset:2152
    ds_read_b128 v[76:79], v21 offset:2432
    ds_read_b128 v[72:75], v21 offset:4992
    s_waitcnt lgkmcnt(6)
    v_and_b32 v80, v80, v156
    v_and_b32 v81, v81, v157
    v_and_b32 v82, v82, v158
    v_and_b32 v83, v83, v159
    s_nop 1
    v_mfma_f32_32x32x16_bf16 v[48:63], v[80:83], v[88:91], v[48:63]
    v_mfma_f32_32x32x16_bf16 v[32:47], v[80:83], v[92:95], v[32:47]
    v_mfma_f32_32x32x16_bf16 v[48:63], v[84:87], v[92:95], v[48:63]
    ds_read_b64 v[80:81], v20 offset:64
    ds_read_b64 v[82:83], v20 offset:72
    ds_read_b64 v[84:85], v20 offset:2112
    ds_read_b64 v[86:87], v20 offset:2120
    ds_read_b128 v[92:95], v21 offset:2400
    ds_read_b128 v[88:91], v21 offset:4960
    s_waitcnt lgkmcnt(6)
    v_mfma_f32_32x32x16_bf16 v[48:63], v[64:67], v[72:75], v[48:63]
    v_mfma_f32_32x32x16_bf16 v[32:47], v[64:67], v[76:79], v[32:47]
    v_mfma_f32_32x32x16_bf16 v[48:63], v[68:71], v[76:79], v[48:63]
    ds_read_b64 v[64:65], v20 offset:160
    ds_read_b64 v[66:67], v20 offset:168
    ds_read_b64 v[68:69], v20 offset:2208
    ds_read_b64 v[70:71], v20 offset:2216
    ds_read_b128 v[76:79], v21 offset:2352
    ds_read_b128 v[72:75], v21 offset:4912
    s_waitcnt lgkmcnt(6)
    v_mfma_f32_32x32x16_bf16 v[48:63], v[80:83], v[88:91], v[48:63]
    v_mfma_f32_32x32x16_bf16 v[32:47], v[80:83], v[92:95], v[32:47]
    v_mfma_f32_32x32x16_bf16 v[48:63], v[84:87], v[92:95], v[48:63]
    ds_read_b64 v[80:81], v20 offset:128
    ds_read_b64 v[82:83], v20 offset:136
    ds_read_b64 v[84:85], v20 offset:2176
    ds_read_b64 v[86:87], v20 offset:2184
    ds_read_b128 v[92:95], v21 offset:2320
    ds_read_b128 v[88:91], v21 offset:4880
    s_waitcnt lgkmcnt(6)
    v_mfma_f32_32x32x16_bf16 v[48:63], v[64:67], v[72:75], v[48:63]
    v_mfma_f32_32x32x16_bf16 v[32:47], v[64:67], v[76:79], v[32:47]
    v_mfma_f32_32x32x16_bf16 v[48:63], v[68:71], v[76:79], v[48:63]
    ds_read_b64 v[64:65], v20 offset:224
    ds_read_b64 v[66:67], v20 offset:232
    ds_read_b64 v[68:69], v20 offset:2272
    ds_read_b64 v[70:71], v20 offset:2280
    ds_read_b128 v[76:79], v21 offset:2272
    ds_read_b128 v[72:75], v21 offset:4832
    s_waitcnt lgkmcnt(6)
    v_mfma_f32_32x32x16_bf16 v[48:63], v[80:83], v[88:91], v[48:63]
    v_mfma_f32_32x32x16_bf16 v[32:47], v[80:83], v[92:95], v[32:47]
    v_mfma_f32_32x32x16_bf16 v[48:63], v[84:87], v[92:95], v[48:63]
    ds_read_b64 v[80:81], v20 offset:192
    ds_read_b64 v[82:83], v20 offset:200
    ds_read_b64 v[84:85], v20 offset:2240
    ds_read_b64 v[86:87], v20 offset:2248
    ds_read_b128 v[92:95], v21 offset:2240
    ds_read_b128 v[88:91], v21 offset:4800
    s_waitcnt lgkmcnt(6)
    v_mfma_f32_32x32x16_bf16 v[48:63], v[64:67], v[72:75], v[48:63]
    v_mfma_f32_32x32x16_bf16 v[32:47], v[64:67], v[76:79], v[32:47]
    v_mfma_f32_32x32x16_bf16 v[48:63], v[68:71], v[76:79], v[48:63]
    ds_read_b64 v[64:65], v20 offset:288
    ds_read_b64 v[66:67], v20 offset:296
    ds_read_b64 v[68:69], v20 offset:2336
    ds_read_b64 v[70:71], v20 offset:2344
    ds_read_b128 v[76:79], v21 offset:2192
    ds_read_b128 v[72:75], v21 offset:4752
    s_waitcnt lgkmcnt(6)
    v_mfma_f32_32x32x16_bf16 v[48:63], v[80:83], v[88:91], v[48:63]
    v_mfma_f32_32x32x16_bf16 v[32:47], v[80:83], v[92:95], v[32:47]
    v_mfma_f32_32x32x16_bf16 v[48:63], v[84:87], v[92:95], v[48:63]
    ds_read_b64 v[80:81], v20 offset:256
    ds_read_b64 v[82:83], v20 offset:264
    ds_read_b64 v[84:85], v20 offset:2304
    ds_read_b64 v[86:87], v20 offset:2312
    ds_read_b128 v[92:95], v21 offset:2160
    ds_read_b128 v[88:91], v21 offset:4720
    s_waitcnt lgkmcnt(6)
    v_mfma_f32_32x32x16_bf16 v[48:63], v[64:67], v[72:75], v[48:63]
    v_mfma_f32_32x32x16_bf16 v[32:47], v[64:67], v[76:79], v[32:47]
    v_mfma_f32_32x32x16_bf16 v[48:63], v[68:71], v[76:79], v[48:63]
    ds_read_b64 v[64:65], v20 offset:352
    ds_read_b64 v[66:67], v20 offset:360
    ds_read_b64 v[68:69], v20 offset:2400
    ds_read_b64 v[70:71], v20 offset:2408
    ds_read_b128 v[76:79], v21 offset:2112
    ds_read_b128 v[72:75], v21 offset:4672
    s_waitcnt lgkmcnt(6)
    v_mfma_f32_32x32x16_bf16 v[48:63], v[80:83], v[88:91], v[48:63]
    v_mfma_f32_32x32x16_bf16 v[32:47], v[80:83], v[92:95], v[32:47]
    v_mfma_f32_32x32x16_bf16 v[48:63], v[84:87], v[92:95], v[48:63]
    ds_read_b64 v[80:81], v20 offset:320
    ds_read_b64 v[82:83], v20 offset:328
    ds_read_b64 v[84:85], v20 offset:2368
    ds_read_b64 v[86:87], v20 offset:2376
    ds_read_b128 v[92:95], v21 offset:2080
    ds_read_b128 v[88:91], v21 offset:4640
    s_waitcnt lgkmcnt(6)
    v_mfma_f32_32x32x16_bf16 v[48:63], v[64:67], v[72:75], v[48:63]
    v_mfma_f32_32x32x16_bf16 v[32:47], v[64:67], v[76:79], v[32:47]
    v_mfma_f32_32x32x16_bf16 v[48:63], v[68:71], v[76:79], v[48:63]
    ds_read_b64 v[64:65], v20 offset:416
    ds_read_b64 v[66:67], v20 offset:424
    ds_read_b64 v[68:69], v20 offset:2464
    ds_read_b64 v[70:71], v20 offset:2472
    ds_read_b128 v[76:79], v21 offset:2032
    ds_read_b128 v[72:75], v21 offset:4592
    s_waitcnt lgkmcnt(6)
    v_mfma_f32_32x32x16_bf16 v[48:63], v[80:83], v[88:91], v[48:63]
    v_mfma_f32_32x32x16_bf16 v[32:47], v[80:83], v[92:95], v[32:47]
    v_mfma_f32_32x32x16_bf16 v[48:63], v[84:87], v[92:95], v[48:63]
    ds_read_b64 v[80:81], v20 offset:384
    ds_read_b64 v[82:83], v20 offset:392
    ds_read_b64 v[84:85], v20 offset:2432
    ds_read_b64 v[86:87], v20 offset:2440
    ds_read_b128 v[92:95], v21 offset:2000
    ds_read_b128 v[88:91], v21 offset:4560
    s_waitcnt lgkmcnt(6)
    v_mfma_f32_32x32x16_bf16 v[48:63], v[64:67], v[72:75], v[48:63]
    v_mfma_f32_32x32x16_bf16 v[32:47], v[64:67], v[76:79], v[32:47]
    v_mfma_f32_32x32x16_bf16 v[48:63], v[68:71], v[76:79], v[48:63]
    ds_read_b64 v[64:65], v20 offset:480
    ds_read_b64 v[66:67], v20 offset:488
    ds_read_b64 v[68:69], v20 offset:2528
    ds_read_b64 v[70:71], v20 offset:2536
    ds_read_b128 v[76:79], v21 offset:1952
    ds_read_b128 v[72:75], v21 offset:4512
    s_waitcnt lgkmcnt(6)
    v_mfma_f32_32x32x16_bf16 v[48:63], v[80:83], v[88:91], v[48:63]
    v_mfma_f32_32x32x16_bf16 v[32:47], v[80:83], v[92:95], v[32:47]
    v_mfma_f32_32x32x16_bf16 v[48:63], v[84:87], v[92:95], v[48:63]
    ds_read_b64 v[80:81], v20 offset:448
    ds_read_b64 v[82:83], v20 offset:456
    ds_read_b64 v[84:85], v20 offset:2496
    ds_read_b64 v[86:87], v20 offset:2504
    ds_read_b128 v[92:95], v21 offset:1920
    ds_read_b128 v[88:91], v21 offset:4480
    s_waitcnt lgkmcnt(6)
    v_mfma_f32_32x32x16_bf16 v[48:63], v[64:67], v[72:75], v[48:63]
    v_mfma_f32_32x32x16_bf16 v[32:47], v[64:67], v[76:79], v[32:47]
    v_mfma_f32_32x32x16_bf16 v[48:63], v[68:71], v[76:79], v[48:63]
    ds_read_b64 v[64:65], v20 offset:544
    ds_read_b64 v[66:67], v20 offset:552
    ds_read_b64 v[68:69], v20 offset:2592
    ds_read_b64 v[70:71], v20 offset:2600
    ds_read_b128 v[76:79], v21 offset:1872
    ds_read_b128 v[72:75], v21 offset:4432
    s_waitcnt lgkmcnt(6)
    v_mfma_f32_32x32x16_bf16 v[48:63], v[80:83], v[88:91], v[48:63]
    v_mfma_f32_32x32x16_bf16 v[32:47], v[80:83], v[92:95], v[32:47]
    v_mfma_f32_32x32x16_bf16 v[48:63], v[84:87], v[92:95], v[48:63]
    ds_read_b64 v[80:81], v20 offset:512
    ds_read_b64 v[82:83], v20 offset:520
    ds_read_b64 v[84:85], v20 offset:2560
    ds_read_b64 v[86:87], v20 offset:2568
    ds_read_b128 v[92:95], v21 offset:1840
    ds_read_b128 v[88:91], v21 offset:4400
    s_waitcnt lgkmcnt(6)
    v_mfma_f32_32x32x16_bf16 v[48:63], v[64:67], v[72:75], v[48:63]
    v_mfma_f32_32x32x16_bf16 v[32:47], v[64:67], v[76:79], v[32:47]
    v_mfma_f32_32x32x16_bf16 v[48:63], v[68:71], v[76:79], v[48:63]
    ds_read_b64 v[64:65], v20 offset:608
    ds_read_b64 v[66:67], v20 offset:616
    ds_read_b64 v[68:69], v20 offset:2656
    ds_read_b64 v[70:71], v20 offset:2664
    ds_read_b128 v[76:79], v21 offset:1792
    ds_read_b128 v[72:75], v21 offset:4352
    s_waitcnt lgkmcnt(6)
    v_mfma_f32_32x32x16_bf16 v[48:63], v[80:83], v[88:91], v[48:63]
    v_mfma_f32_32x32x16_bf16 v[32:47], v[80:83], v[92:95], v[32:47]
    v_mfma_f32_32x32x16_bf16 v[48:63], v[84:87], v[92:95], v[48:63]
    ds_read_b64 v[80:81], v20 offset:576
    ds_read_b64 v[82:83], v20 offset:584
    ds_read_b64 v[84:85], v20 offset:2624
    ds_read_b64 v[86:87], v20 offset:2632
    ds_read_b128 v[92:95], v21 offset:1760
    ds_read_b128 v[88:91], v21 offset:4320
    s_waitcnt lgkmcnt(6)
    v_mfma_f32_32x32x16_bf16 v[48:63], v[64:67], v[72:75], v[48:63]
    v_mfma_f32_32x32x16_bf16 v[32:47], v[64:67], v[76:79], v[32:47]
    v_mfma_f32_32x32x16_bf16 v[48:63], v[68:71], v[76:79], v[48:63]
    ds_read_b64 v[64:65], v20 offset:672
    ds_read_b64 v[66:67], v20 offset:680
    ds_read_b64 v[68:69], v20 offset:2720
    ds_read_b64 v[70:71], v20 offset:2728
    ds_read_b128 v[76:79], v21 offset:1712
    ds_read_b128 v[72:75], v21 offset:4272
    s_waitcnt lgkmcnt(6)
    v_mfma_f32_32x32x16_bf16 v[48:63], v[80:83], v[88:91], v[48:63]
    v_mfma_f32_32x32x16_bf16 v[32:47], v[80:83], v[92:95], v[32:47]
    v_mfma_f32_32x32x16_bf16 v[48:63], v[84:87], v[92:95], v[48:63]
    ds_read_b64 v[80:81], v20 offset:640
    ds_read_b64 v[82:83], v20 offset:648
    ds_read_b64 v[84:85], v20 offset:2688
    ds_read_b64 v[86:87], v20 offset:2696
    ds_read_b128 v[92:95], v21 offset:1680
    ds_read_b128 v[88:91], v21 offset:4240
    s_waitcnt lgkmcnt(6)
    v_mfma_f32_32x32x16_bf16 v[48:63], v[64:67], v[72:75], v[48:63]
    v_mfma_f32_32x32x16_bf16 v[32:47], v[64:67], v[76:79], v[32:47]
    v_mfma_f32_32x32x16_bf16 v[48:63], v[68:71], v[76:79], v[48:63]
    ds_read_b64 v[64:65], v20 offset:736
    ds_read_b64 v[66:67], v20 offset:744
    ds_read_b64 v[68:69], v20 offset:2784
    ds_read_b64 v[70:71], v20 offset:2792
    ds_read_b128 v[76:79], v21 offset:1632
    ds_read_b128 v[72:75], v21 offset:4192
    s_waitcnt lgkmcnt(6)
    v_mfma_f32_32x32x16_bf16 v[48:63], v[80:83], v[88:91], v[48:63]
    v_mfma_f32_32x32x16_bf16 v[32:47], v[80:83], v[92:95], v[32:47]
    v_mfma_f32_32x32x16_bf16 v[48:63], v[84:87], v[92:95], v[48:63]
    ds_read_b64 v[80:81], v20 offset:704
    ds_read_b64 v[82:83], v20 offset:712
    ds_read_b64 v[84:85], v20 offset:2752
    ds_read_b64 v[86:87], v20 offset:2760
    ds_read_b128 v[92:95], v21 offset:1600
    ds_read_b128 v[88:91], v21 offset:4160
    s_waitcnt lgkmcnt(6)
    v_mfma_f32_32x32x16_bf16 v[48:63], v[64:67], v[72:75], v[48:63]
    v_mfma_f32_32x32x16_bf16 v[32:47], v[64:67], v[76:79], v[32:47]
    v_mfma_f32_32x32x16_bf16 v[48:63], v[68:71], v[76:79], v[48:63]
    ds_read_b64 v[64:65], v20 offset:800
    ds_read_b64 v[66:67], v20 offset:808
    ds_read_b64 v[68:69], v20 offset:2848
    ds_read_b64 v[70:71], v20 offset:2856
    ds_read_b128 v[76:79], v21 offset:1552
    ds_read_b128 v[72:75], v21 offset:4112
    s_waitcnt lgkmcnt(6)
    v_mfma_f32_32x32x16_bf16 v[48:63], v[80:83], v[88:91], v[48:63]
    v_mfma_f32_32x32x16_bf16 v[32:47], v[80:83], v[92:95], v[32:47]
    v_mfma_f32_32x32x16_bf16 v[48:63], v[84:87], v[92:95], v[48:63]
    ds_read_b64 v[80:81], v20 offset:768
    ds_read_b64 v[82:83], v20 offset:776
    ds_read_b64 v[84:85], v20 offset:2816
    ds_read_b64 v[86:87], v20 offset:2824
    ds_read_b128 v[92:95], v21 offset:1520
    ds_read_b128 v[88:91], v21 offset:4080
    s_waitcnt lgkmcnt(6)
    v_mfma_f32_32x32x16_bf16 v[48:63], v[64:67], v[72:75], v[48:63]
    v_mfma_f32_32x32x16_bf16 v[32:47], v[64:67], v[76:79], v[32:47]
    v_mfma_f32_32x32x16_bf16 v[48:63], v[68:71], v[76:79], v[48:63]
    ds_read_b64 v[64:65], v20 offset:864
    ds_read_b64 v[66:67], v20 offset:872
    ds_read_b64 v[68:69], v20 offset:2912
    ds_read_b64 v[70:71], v20 offset:2920
    ds_read_b128 v[76:79], v21 offset:1472
    ds_read_b128 v[72:75], v21 offset:4032
    s_waitcnt lgkmcnt(6)
    v_mfma_f32_32x32x16_bf16 v[48:63], v[80:83], v[88:91], v[48:63]
    v_mfma_f32_32x32x16_bf16 v[32:47], v[80:83], v[92:95], v[32:47]
    v_mfma_f32_32x32x16_bf16 v[48:63], v[84:87], v[92:95], v[48:63]
    ds_read_b64 v[80:81], v20 offset:832
    ds_read_b64 v[82:83], v20 offset:840
    ds_read_b64 v[84:85], v20 offset:2880
    ds_read_b64 v[86:87], v20 offset:2888
    ds_read_b128 v[92:95], v21 offset:1440
    ds_read_b128 v[88:91], v21 offset:4000
    s_waitcnt lgkmcnt(6)
    v_mfma_f32_32x32x16_bf16 v[48:63], v[64:67], v[72:75], v[48:63]
    v_mfma_f32_32x32x16_bf16 v[32:47], v[64:67], v[76:79], v[32:47]
    v_mfma_f32_32x32x16_bf16 v[48:63], v[68:71], v[76:79], v[48:63]
    ds_read_b64 v[64:65], v20 offset:928
    ds_read_b64 v[66:67], v20 offset:936
    ds_read_b64 v[68:69], v20 offset:2976
    ds_read_b64 v[70:71], v20 offset:2984
    ds_read_b128 v[76:79], v21 offset:1392
    ds_read_b128 v[72:75], v21 offset:3952
    s_waitcnt lgkmcnt(6)
    v_mfma_f32_32x32x16_bf16 v[48:63], v[80:83], v[88:91], v[48:63]
    v_mfma_f32_32x32x16_bf16 v[32:47], v[80:83], v[92:95], v[32:47]
    v_mfma_f32_32x32x16_bf16 v[48:63], v[84:87], v[92:95], v[48:63]
    ds_read_b64 v[80:81], v20 offset:896
    ds_read_b64 v[82:83], v20 offset:904
    ds_read_b64 v[84:85], v20 offset:2944
    ds_read_b64 v[86:87], v20 offset:2952
    ds_read_b128 v[92:95], v21 offset:1360
    ds_read_b128 v[88:91], v21 offset:3920
    s_waitcnt lgkmcnt(6)
    v_mfma_f32_32x32x16_bf16 v[48:63], v[64:67], v[72:75], v[48:63]
    v_mfma_f32_32x32x16_bf16 v[32:47], v[64:67], v[76:79], v[32:47]
    v_mfma_f32_32x32x16_bf16 v[48:63], v[68:71], v[76:79], v[48:63]
    ds_read_b64 v[64:65], v20 offset:992
    ds_read_b64 v[66:67], v20 offset:1000
    ds_read_b64 v[68:69], v20 offset:3040
    ds_read_b64 v[70:71], v20 offset:3048
    ds_read_b128 v[76:79], v21 offset:1312
    ds_read_b128 v[72:75], v21 offset:3872
    s_waitcnt lgkmcnt(6)
    v_mfma_f32_32x32x16_bf16 v[48:63], v[80:83], v[88:91], v[48:63]
    v_mfma_f32_32x32x16_bf16 v[32:47], v[80:83], v[92:95], v[32:47]
    v_mfma_f32_32x32x16_bf16 v[48:63], v[84:87], v[92:95], v[48:63]
    ds_read_b64 v[80:81], v20 offset:960
    ds_read_b64 v[82:83], v20 offset:968
    ds_read_b64 v[84:85], v20 offset:3008
    ds_read_b64 v[86:87], v20 offset:3016
    ds_read_b128 v[92:95], v21 offset:1280
    ds_read_b128 v[88:91], v21 offset:3840
    s_waitcnt lgkmcnt(6)
    v_mfma_f32_32x32x16_bf16 v[48:63], v[64:67], v[72:75], v[48:63]
    v_mfma_f32_32x32x16_bf16 v[32:47], v[64:67], v[76:79], v[32:47]
    v_mfma_f32_32x32x16_bf16 v[48:63], v[68:71], v[76:79], v[48:63]
    ds_read_b64 v[64:65], v20 offset:1056
    ds_read_b64 v[66:67], v20 offset:1064
    ds_read_b64 v[68:69], v20 offset:3104
    ds_read_b64 v[70:71], v20 offset:3112
    ds_read_b128 v[76:79], v21 offset:1232
    ds_read_b128 v[72:75], v21 offset:3792
    s_waitcnt lgkmcnt(6)
    v_mfma_f32_32x32x16_bf16 v[48:63], v[80:83], v[88:91], v[48:63]
    v_mfma_f32_32x32x16_bf16 v[32:47], v[80:83], v[92:95], v[32:47]
    v_mfma_f32_32x32x16_bf16 v[48:63], v[84:87], v[92:95], v[48:63]
    ds_read_b64 v[80:81], v20 offset:1024
    ds_read_b64 v[82:83], v20 offset:1032
    ds_read_b64 v[84:85], v20 offset:3072
    ds_read_b64 v[86:87], v20 offset:3080
    ds_read_b128 v[92:95], v21 offset:1200
    ds_read_b128 v[88:91], v21 offset:3760
    s_waitcnt lgkmcnt(6)
    v_mfma_f32_32x32x16_bf16 v[48:63], v[64:67], v[72:75], v[48:63]
    v_mfma_f32_32x32x16_bf16 v[32:47], v[64:67], v[76:79], v[32:47]
    v_mfma_f32_32x32x16_bf16 v[48:63], v[68:71], v[76:79], v[48:63]
    ds_read_b64 v[64:65], v20 offset:1120
    ds_read_b64 v[66:67], v20 offset:1128
    ds_read_b64 v[68:69], v20 offset:3168
    ds_read_b64 v[70:71], v20 offset:3176
    ds_read_b128 v[76:79], v21 offset:1152
    ds_read_b128 v[72:75], v21 offset:3712
    s_waitcnt lgkmcnt(6)
    v_mfma_f32_32x32x16_bf16 v[48:63], v[80:83], v[88:91], v[48:63]
    v_mfma_f32_32x32x16_bf16 v[32:47], v[80:83], v[92:95], v[32:47]
    v_mfma_f32_32x32x16_bf16 v[48:63], v[84:87], v[92:95], v[48:63]
    ds_read_b64 v[80:81], v20 offset:1088
    ds_read_b64 v[82:83], v20 offset:1096
    ds_read_b64 v[84:85], v20 offset:3136
    ds_read_b64 v[86:87], v20 offset:3144
    ds_read_b128 v[92:95], v21 offset:1120
    ds_read_b128 v[88:91], v21 offset:3680
    s_waitcnt lgkmcnt(6)
    v_mfma_f32_32x32x16_bf16 v[48:63], v[64:67], v[72:75], v[48:63]
    v_mfma_f32_32x32x16_bf16 v[32:47], v[64:67], v[76:79], v[32:47]
    v_mfma_f32_32x32x16_bf16 v[48:63], v[68:71], v[76:79], v[48:63]
    ds_read_b64 v[64:65], v20 offset:1184
    ds_read_b64 v[66:67], v20 offset:1192
    ds_read_b64 v[68:69], v20 offset:3232
    ds_read_b64 v[70:71], v20 offset:3240
    ds_read_b128 v[76:79], v21 offset:1072
    ds_read_b128 v[72:75], v21 offset:3632
    s_waitcnt lgkmcnt(6)
    v_mfma_f32_32x32x16_bf16 v[48:63], v[80:83], v[88:91], v[48:63]
    v_mfma_f32_32x32x16_bf16 v[32:47], v[80:83], v[92:95], v[32:47]
    v_mfma_f32_32x32x16_bf16 v[48:63], v[84:87], v[92:95], v[48:63]
    ds_read_b64 v[80:81], v20 offset:1152
    ds_read_b64 v[82:83], v20 offset:1160
    ds_read_b64 v[84:85], v20 offset:3200
    ds_read_b64 v[86:87], v20 offset:3208
    ds_read_b128 v[92:95], v21 offset:1040
    ds_read_b128 v[88:91], v21 offset:3600
    s_waitcnt lgkmcnt(6)
    v_mfma_f32_32x32x16_bf16 v[48:63], v[64:67], v[72:75], v[48:63]
    v_mfma_f32_32x32x16_bf16 v[32:47], v[64:67], v[76:79], v[32:47]
    v_mfma_f32_32x32x16_bf16 v[48:63], v[68:71], v[76:79], v[48:63]
    ds_read_b64 v[64:65], v20 offset:1248
    ds_read_b64 v[66:67], v20 offset:1256
    ds_read_b64 v[68:69], v20 offset:3296
    ds_read_b64 v[70:71], v20 offset:3304
    ds_read_b128 v[76:79], v21 offset:992
    ds_read_b128 v[72:75], v21 offset:3552
    s_waitcnt lgkmcnt(6)
    v_mfma_f32_32x32x16_bf16 v[48:63], v[80:83], v[88:91], v[48:63]
    v_mfma_f32_32x32x16_bf16 v[32:47], v[80:83], v[92:95], v[32:47]
    v_mfma_f32_32x32x16_bf16 v[48:63], v[84:87], v[92:95], v[48:63]
    ds_read_b64 v[80:81], v20 offset:1216
    ds_read_b64 v[82:83], v20 offset:1224
    ds_read_b64 v[84:85], v20 offset:3264
    ds_read_b64 v[86:87], v20 offset:3272
    ds_read_b128 v[92:95], v21 offset:960
    ds_read_b128 v[88:91], v21 offset:3520
    s_waitcnt lgkmcnt(6)
    v_mfma_f32_32x32x16_bf16 v[48:63], v[64:67], v[72:75], v[48:63]
    v_mfma_f32_32x32x16_bf16 v[32:47], v[64:67], v[76:79], v[32:47]
    v_mfma_f32_32x32x16_bf16 v[48:63], v[68:71], v[76:79], v[48:63]
    ds_read_b64 v[64:65], v20 offset:1312
    ds_read_b64 v[66:67], v20 offset:1320
    ds_read_b64 v[68:69], v20 offset:3360
    ds_read_b64 v[70:71], v20 offset:3368
    ds_read_b128 v[76:79], v21 offset:912
    ds_read_b128 v[72:75], v21 offset:3472
    s_waitcnt lgkmcnt(6)
    v_mfma_f32_32x32x16_bf16 v[48:63], v[80:83], v[88:91], v[48:63]
    v_mfma_f32_32x32x16_bf16 v[32:47], v[80:83], v[92:95], v[32:47]
    v_mfma_f32_32x32x16_bf16 v[48:63], v[84:87], v[92:95], v[48:63]
    ds_read_b64 v[80:81], v20 offset:1280
    ds_read_b64 v[82:83], v20 offset:1288
    ds_read_b64 v[84:85], v20 offset:3328
    ds_read_b64 v[86:87], v20 offset:3336
    ds_read_b128 v[92:95], v21 offset:880
    ds_read_b128 v[88:91], v21 offset:3440
    s_waitcnt lgkmcnt(6)
    v_mfma_f32_32x32x16_bf16 v[48:63], v[64:67], v[72:75], v[48:63]
    v_mfma_f32_32x32x16_bf16 v[32:47], v[64:67], v[76:79], v[32:47]
    v_mfma_f32_32x32x16_bf16 v[48:63], v[68:71], v[76:79], v[48:63]
    ds_read_b64 v[64:65], v20 offset:1376
    ds_read_b64 v[66:67], v20 offset:1384
    ds_read_b64 v[68:69], v20 offset:3424
    ds_read_b64 v[70:71], v20 offset:3432
    ds_read_b128 v[76:79], v21 offset:832
    ds_read_b128 v[72:75], v21 offset:3392
    s_waitcnt lgkmcnt(6)
    v_mfma_f32_32x32x16_bf16 v[48:63], v[80:83], v[88:91], v[48:63]
    v_mfma_f32_32x32x16_bf16 v[32:47], v[80:83], v[92:95], v[32:47]
    v_mfma_f32_32x32x16_bf16 v[48:63], v[84:87], v[92:95], v[48:63]
    ds_read_b64 v[80:81], v20 offset:1344
    ds_read_b64 v[82:83], v20 offset:1352
    ds_read_b64 v[84:85], v20 offset:3392
    ds_read_b64 v[86:87], v20 offset:3400
    ds_read_b128 v[92:95], v21 offset:800
    ds_read_b128 v[88:91], v21 offset:3360
    s_waitcnt lgkmcnt(6)
    v_mfma_f32_32x32x16_bf16 v[48:63], v[64:67], v[72:75], v[48:63]
    v_mfma_f32_32x32x16_bf16 v[32:47], v[64:67], v[76:79], v[32:47]
    v_mfma_f32_32x32x16_bf16 v[48:63], v[68:71], v[76:79], v[48:63]
    ds_read_b64 v[64:65], v20 offset:1440
    ds_read_b64 v[66:67], v20 offset:1448
    ds_read_b64 v[68:69], v20 offset:3488
    ds_read_b64 v[70:71], v20 offset:3496
    ds_read_b128 v[76:79], v21 offset:752
    ds_read_b128 v[72:75], v21 offset:3312
    s_waitcnt lgkmcnt(6)
    v_mfma_f32_32x32x16_bf16 v[48:63], v[80:83], v[88:91], v[48:63]
    v_mfma_f32_32x32x16_bf16 v[32:47], v[80:83], v[92:95], v[32:47]
    v_mfma_f32_32x32x16_bf16 v[48:63], v[84:87], v[92:95], v[48:63]
    ds_read_b64 v[80:81], v20 offset:1408
    ds_read_b64 v[82:83], v20 offset:1416
    ds_read_b64 v[84:85], v20 offset:3456
    ds_read_b64 v[86:87], v20 offset:3464
    ds_read_b128 v[92:95], v21 offset:720
    ds_read_b128 v[88:91], v21 offset:3280
    s_waitcnt lgkmcnt(6)
    v_mfma_f32_32x32x16_bf16 v[48:63], v[64:67], v[72:75], v[48:63]
    v_mfma_f32_32x32x16_bf16 v[32:47], v[64:67], v[76:79], v[32:47]
    v_mfma_f32_32x32x16_bf16 v[48:63], v[68:71], v[76:79], v[48:63]
    ds_read_b64 v[64:65], v20 offset:1504
    ds_read_b64 v[66:67], v20 offset:1512
    ds_read_b64 v[68:69], v20 offset:3552
    ds_read_b64 v[70:71], v20 offset:3560
    ds_read_b128 v[76:79], v21 offset:672
    ds_read_b128 v[72:75], v21 offset:3232
    s_waitcnt lgkmcnt(6)
    v_mfma_f32_32x32x16_bf16 v[48:63], v[80:83], v[88:91], v[48:63]
    v_mfma_f32_32x32x16_bf16 v[32:47], v[80:83], v[92:95], v[32:47]
    v_mfma_f32_32x32x16_bf16 v[48:63], v[84:87], v[92:95], v[48:63]
    ds_read_b64 v[80:81], v20 offset:1472
    ds_read_b64 v[82:83], v20 offset:1480
    ds_read_b64 v[84:85], v20 offset:3520
    ds_read_b64 v[86:87], v20 offset:3528
    ds_read_b128 v[92:95], v21 offset:640
    ds_read_b128 v[88:91], v21 offset:3200
    s_waitcnt lgkmcnt(6)
    v_mfma_f32_32x32x16_bf16 v[48:63], v[64:67], v[72:75], v[48:63]
    v_mfma_f32_32x32x16_bf16 v[32:47], v[64:67], v[76:79], v[32:47]
    v_mfma_f32_32x32x16_bf16 v[48:63], v[68:71], v[76:79], v[48:63]
    ds_read_b64 v[64:65], v20 offset:1568
    ds_read_b64 v[66:67], v20 offset:1576
    ds_read_b64 v[68:69], v20 offset:3616
    ds_read_b64 v[70:71], v20 offset:3624
    ds_read_b128 v[76:79], v21 offset:592
    ds_read_b128 v[72:75], v21 offset:3152
    s_waitcnt lgkmcnt(6)
    v_mfma_f32_32x32x16_bf16 v[48:63], v[80:83], v[88:91], v[48:63]
    v_mfma_f32_32x32x16_bf16 v[32:47], v[80:83], v[92:95], v[32:47]
    v_mfma_f32_32x32x16_bf16 v[48:63], v[84:87], v[92:95], v[48:63]
    ds_read_b64 v[80:81], v20 offset:1536
    ds_read_b64 v[82:83], v20 offset:1544
    ds_read_b64 v[84:85], v20 offset:3584
    ds_read_b64 v[86:87], v20 offset:3592
    ds_read_b128 v[92:95], v21 offset:560
    ds_read_b128 v[88:91], v21 offset:3120
    s_waitcnt lgkmcnt(6)
    v_mfma_f32_32x32x16_bf16 v[48:63], v[64:67], v[72:75], v[48:63]
    v_mfma_f32_32x32x16_bf16 v[32:47], v[64:67], v[76:79], v[32:47]
    v_mfma_f32_32x32x16_bf16 v[48:63], v[68:71], v[76:79], v[48:63]
    ds_read_b64 v[64:65], v20 offset:1632
    ds_read_b64 v[66:67], v20 offset:1640
    ds_read_b64 v[68:69], v20 offset:3680
    ds_read_b64 v[70:71], v20 offset:3688
    ds_read_b128 v[76:79], v21 offset:512
    ds_read_b128 v[72:75], v21 offset:3072
    s_waitcnt lgkmcnt(6)
    v_mfma_f32_32x32x16_bf16 v[48:63], v[80:83], v[88:91], v[48:63]
    v_mfma_f32_32x32x16_bf16 v[32:47], v[80:83], v[92:95], v[32:47]
    v_mfma_f32_32x32x16_bf16 v[48:63], v[84:87], v[92:95], v[48:63]
    ds_read_b64 v[80:81], v20 offset:1600
    ds_read_b64 v[82:83], v20 offset:1608
    ds_read_b64 v[84:85], v20 offset:3648
    ds_read_b64 v[86:87], v20 offset:3656
    ds_read_b128 v[92:95], v21 offset:480
    ds_read_b128 v[88:91], v21 offset:3040
    s_waitcnt lgkmcnt(6)
    v_mfma_f32_32x32x16_bf16 v[48:63], v[64:67], v[72:75], v[48:63]
    v_mfma_f32_32x32x16_bf16 v[32:47], v[64:67], v[76:79], v[32:47]
    v_mfma_f32_32x32x16_bf16 v[48:63], v[68:71], v[76:79], v[48:63]
    ds_read_b64 v[64:65], v20 offset:1696
    ds_read_b64 v[66:67], v20 offset:1704
    ds_read_b64 v[68:69], v20 offset:3744
    ds_read_b64 v[70:71], v20 offset:3752
    ds_read_b128 v[76:79], v21 offset:432
    ds_read_b128 v[72:75], v21 offset:2992
    s_waitcnt lgkmcnt(6)
    v_mfma_f32_32x32x16_bf16 v[48:63], v[80:83], v[88:91], v[48:63]
    v_mfma_f32_32x32x16_bf16 v[32:47], v[80:83], v[92:95], v[32:47]
    v_mfma_f32_32x32x16_bf16 v[48:63], v[84:87], v[92:95], v[48:63]
    ds_read_b64 v[80:81], v20 offset:1664
    ds_read_b64 v[82:83], v20 offset:1672
    ds_read_b64 v[84:85], v20 offset:3712
    ds_read_b64 v[86:87], v20 offset:3720
    ds_read_b128 v[92:95], v21 offset:400
    ds_read_b128 v[88:91], v21 offset:2960
    s_waitcnt lgkmcnt(6)
    v_mfma_f32_32x32x16_bf16 v[48:63], v[64:67], v[72:75], v[48:63]
    v_mfma_f32_32x32x16_bf16 v[32:47], v[64:67], v[76:79], v[32:47]
    v_mfma_f32_32x32x16_bf16 v[48:63], v[68:71], v[76:79], v[48:63]
    ds_read_b64 v[64:65], v20 offset:1760
    ds_read_b64 v[66:67], v20 offset:1768
    ds_read_b64 v[68:69], v20 offset:3808
    ds_read_b64 v[70:71], v20 offset:3816
    ds_read_b128 v[76:79], v21 offset:352
    ds_read_b128 v[72:75], v21 offset:2912
    s_waitcnt lgkmcnt(6)
    v_mfma_f32_32x32x16_bf16 v[48:63], v[80:83], v[88:91], v[48:63]
    v_mfma_f32_32x32x16_bf16 v[32:47], v[80:83], v[92:95], v[32:47]
    v_mfma_f32_32x32x16_bf16 v[48:63], v[84:87], v[92:95], v[48:63]
    ds_read_b64 v[80:81], v20 offset:1728
    ds_read_b64 v[82:83], v20 offset:1736
    ds_read_b64 v[84:85], v20 offset:3776
    ds_read_b64 v[86:87], v20 offset:3784
    ds_read_b128 v[92:95], v21 offset:320
    ds_read_b128 v[88:91], v21 offset:2880
    s_waitcnt lgkmcnt(6)
    v_mfma_f32_32x32x16_bf16 v[48:63], v[64:67], v[72:75], v[48:63]
    v_mfma_f32_32x32x16_bf16 v[32:47], v[64:67], v[76:79], v[32:47]
    v_mfma_f32_32x32x16_bf16 v[48:63], v[68:71], v[76:79], v[48:63]
    ds_read_b64 v[64:65], v20 offset:1824
    ds_read_b64 v[66:67], v20 offset:1832
    ds_read_b64 v[68:69], v20 offset:3872
    ds_read_b64 v[70:71], v20 offset:3880
    ds_read_b128 v[76:79], v21 offset:272
    ds_read_b128 v[72:75], v21 offset:2832
    s_waitcnt lgkmcnt(6)
    v_mfma_f32_32x32x16_bf16 v[48:63], v[80:83], v[88:91], v[48:63]
    v_mfma_f32_32x32x16_bf16 v[32:47], v[80:83], v[92:95], v[32:47]
    v_mfma_f32_32x32x16_bf16 v[48:63], v[84:87], v[92:95], v[48:63]
    ds_read_b64 v[80:81], v20 offset:1792
    ds_read_b64 v[82:83], v20 offset:1800
    ds_read_b64 v[84:85], v20 offset:3840
    ds_read_b64 v[86:87], v20 offset:3848
    ds_read_b128 v[92:95], v21 offset:240
    ds_read_b128 v[88:91], v21 offset:2800
    s_waitcnt lgkmcnt(6)
    v_mfma_f32_32x32x16_bf16 v[48:63], v[64:67], v[72:75], v[48:63]
    v_mfma_f32_32x32x16_bf16 v[32:47], v[64:67], v[76:79], v[32:47]
    v_mfma_f32_32x32x16_bf16 v[48:63], v[68:71], v[76:79], v[48:63]
    ds_read_b64 v[64:65], v20 offset:1888
    ds_read_b64 v[66:67], v20 offset:1896
    ds_read_b64 v[68:69], v20 offset:3936
    ds_read_b64 v[70:71], v20 offset:3944
    ds_read_b128 v[76:79], v21 offset:192
    ds_read_b128 v[72:75], v21 offset:2752
    s_waitcnt lgkmcnt(6)
    v_mfma_f32_32x32x16_bf16 v[48:63], v[80:83], v[88:91], v[48:63]
    v_mfma_f32_32x32x16_bf16 v[32:47], v[80:83], v[92:95], v[32:47]
    v_mfma_f32_32x32x16_bf16 v[48:63], v[84:87], v[92:95], v[48:63]
    ds_read_b64 v[80:81], v20 offset:1856
    ds_read_b64 v[82:83], v20 offset:1864
    ds_read_b64 v[84:85], v20 offset:3904
    ds_read_b64 v[86:87], v20 offset:3912
    ds_read_b128 v[92:95], v21 offset:160
    ds_read_b128 v[88:91], v21 offset:2720
    s_waitcnt lgkmcnt(6)
    v_mfma_f32_32x32x16_bf16 v[48:63], v[64:67], v[72:75], v[48:63]
    v_mfma_f32_32x32x16_bf16 v[32:47], v[64:67], v[76:79], v[32:47]
    v_mfma_f32_32x32x16_bf16 v[48:63], v[68:71], v[76:79], v[48:63]
    ds_read_b64 v[64:65], v20 offset:1952
    ds_read_b64 v[66:67], v20 offset:1960
    ds_read_b64 v[68:69], v20 offset:4000
    ds_read_b64 v[70:71], v20 offset:4008
    ds_read_b128 v[76:79], v21 offset:112
    ds_read_b128 v[72:75], v21 offset:2672
    s_waitcnt lgkmcnt(6)
    v_mfma_f32_32x32x16_bf16 v[48:63], v[80:83], v[88:91], v[48:63]
    v_mfma_f32_32x32x16_bf16 v[32:47], v[80:83], v[92:95], v[32:47]
    v_mfma_f32_32x32x16_bf16 v[48:63], v[84:87], v[92:95], v[48:63]
    ds_read_b64 v[80:81], v20 offset:1920
    ds_read_b64 v[82:83], v20 offset:1928
    ds_read_b64 v[84:85], v20 offset:3968
    ds_read_b64 v[86:87], v20 offset:3976
    ds_read_b128 v[92:95], v21 offset:80
    ds_read_b128 v[88:91], v21 offset:2640
    s_waitcnt lgkmcnt(6)
    v_mfma_f32_32x32x16_bf16 v[48:63], v[64:67], v[72:75], v[48:63]
    v_mfma_f32_32x32x16_bf16 v[32:47], v[64:67], v[76:79], v[32:47]
    v_mfma_f32_32x32x16_bf16 v[48:63], v[68:71], v[76:79], v[48:63]
    ds_read_b64 v[64:65], v20 offset:2016
    ds_read_b64 v[66:67], v20 offset:2024
    ds_read_b64 v[68:69], v20 offset:4064
    ds_read_b64 v[70:71], v20 offset:4072
    ds_read_b128 v[76:79], v21 offset:32
    ds_read_b128 v[72:75], v21 offset:2592
    s_waitcnt lgkmcnt(6)
    v_mfma_f32_32x32x16_bf16 v[48:63], v[80:83], v[88:91], v[48:63]
    v_mfma_f32_32x32x16_bf16 v[32:47], v[80:83], v[92:95], v[32:47]
    v_mfma_f32_32x32x16_bf16 v[48:63], v[84:87], v[92:95], v[48:63]
    ds_read_b64 v[80:81], v20 offset:1984
    ds_read_b64 v[82:83], v20 offset:1992
    ds_read_b64 v[84:85], v20 offset:4032
    ds_read_b64 v[86:87], v20 offset:4040
    ds_read_b128 v[92:95], v21 offset:0
    ds_read_b128 v[88:91], v21 offset:2560
    s_waitcnt lgkmcnt(6)
    v_mfma_f32_32x32x16_bf16 v[48:63], v[64:67], v[72:75], v[48:63]
    v_mfma_f32_32x32x16_bf16 v[32:47], v[64:67], v[76:79], v[32:47]
    v_mfma_f32_32x32x16_bf16 v[48:63], v[68:71], v[76:79], v[48:63]
    s_waitcnt lgkmcnt(0)
    v_mfma_f32_32x32x16_bf16 v[48:63], v[80:83], v[88:91], v[48:63]
    v_mfma_f32_32x32x16_bf16 v[32:47], v[80:83], v[92:95], v[32:47]
    v_mfma_f32_32x32x16_bf16 v[48:63], v[84:87], v[92:95], v[48:63]
    ds_read_b64 v[96:97], v22 offset:48
    ds_read_b64 v[98:99], v22 offset:32
    ds_read_b64 v[100:101], v22 offset:16
    ds_read_b64 v[102:103], v22 offset:0
    ds_read_b64 v[104:105], v22 offset:2608
    ds_read_b64 v[106:107], v22 offset:2592
    ds_read_b64 v[108:109], v22 offset:2576
    ds_read_b64 v[110:111], v22 offset:2560
    s_nop 7
    s_nop 7
    s_waitcnt lgkmcnt(0)
    v_mov_b32 v10, v9
    v_mov_b32 v11, v9
    v_and_b32 v120, 0xffff0000, v97
    v_lshlrev_b32 v121, 16, v97
    v_pk_mul_f32 v[120:121], v[120:121], v[10:11]
    v_cvt_pk_bf16_f32 v124, v120, v121
    v_lshlrev_b32 v120, 16, v124
    v_and_b32 v121, 0xffff0000, v124
    v_cvt_pk_bf16_f32 v124, v32, v33
    v_lshlrev_b32 v122, 16, v124
    v_and_b32 v123, 0xffff0000, v124
    v_pk_add_f32 v[122:123], v[122:123], v[120:121]
    v_cvt_pk_bf16_f32 v126, v122, v123
    v_and_b32 v120, 0xffff0000, v96
    v_lshlrev_b32 v121, 16, v96
    v_pk_mul_f32 v[120:121], v[120:121], v[10:11]
    v_cvt_pk_bf16_f32 v124, v120, v121
    v_lshlrev_b32 v120, 16, v124
    v_and_b32 v121, 0xffff0000, v124
    v_cvt_pk_bf16_f32 v124, v34, v35
    v_lshlrev_b32 v122, 16, v124
    v_and_b32 v123, 0xffff0000, v124
    v_pk_add_f32 v[122:123], v[122:123], v[120:121]
    v_cvt_pk_bf16_f32 v127, v122, v123
    buffer_store_dwordx2 v[126:127], v23, s[40:43], 0 offen offset:0
    s_nop 0
    v_and_b32 v120, 0xffff0000, v99
    v_lshlrev_b32 v121, 16, v99
    v_pk_mul_f32 v[120:121], v[120:121], v[10:11]
    v_cvt_pk_bf16_f32 v124, v120, v121
    v_lshlrev_b32 v120, 16, v124
    v_and_b32 v121, 0xffff0000, v124
    v_cvt_pk_bf16_f32 v124, v36, v37
    v_lshlrev_b32 v122, 16, v124
    v_and_b32 v123, 0xffff0000, v124
    v_pk_add_f32 v[122:123], v[122:123], v[120:121]
    v_cvt_pk_bf16_f32 v126, v122, v123
    v_and_b32 v120, 0xffff0000, v98
    v_lshlrev_b32 v121, 16, v98
    v_pk_mul_f32 v[120:121], v[120:121], v[10:11]
    v_cvt_pk_bf16_f32 v124, v120, v121
    v_lshlrev_b32 v120, 16, v124
    v_and_b32 v121, 0xffff0000, v124
    v_cvt_pk_bf16_f32 v124, v38, v39
    v_lshlrev_b32 v122, 16, v124
    v_and_b32 v123, 0xffff0000, v124
    v_pk_add_f32 v[122:123], v[122:123], v[120:121]
    v_cvt_pk_bf16_f32 v127, v122, v123
    buffer_store_dwordx2 v[126:127], v23, s[40:43], 0 offen offset:16
    s_nop 0
    v_and_b32 v120, 0xffff0000, v101
    v_lshlrev_b32 v121, 16, v101
    v_pk_mul_f32 v[120:121], v[120:121], v[10:11]
    v_cvt_pk_bf16_f32 v124, v120, v121
    v_lshlrev_b32 v120, 16, v124
    v_and_b32 v121, 0xffff0000, v124
    v_cvt_pk_bf16_f32 v124, v40, v41
    v_lshlrev_b32 v122, 16, v124
    v_and_b32 v123, 0xffff0000, v124
    v_pk_add_f32 v[122:123], v[122:123], v[120:121]
    v_cvt_pk_bf16_f32 v126, v122, v123
    v_and_b32 v120, 0xffff0000, v100
    v_lshlrev_b32 v121, 16, v100
    v_pk_mul_f32 v[120:121], v[120:121], v[10:11]
    v_cvt_pk_bf16_f32 v124, v120, v121
    v_lshlrev_b32 v120, 16, v124
    v_and_b32 v121, 0xffff0000, v124
    v_cvt_pk_bf16_f32 v124, v42, v43
    v_lshlrev_b32 v122, 16, v124
    v_and_b32 v123, 0xffff0000, v124
    v_pk_add_f32 v[122:123], v[122:123], v[120:121]
    v_cvt_pk_bf16_f32 v127, v122, v123
    buffer_store_dwordx2 v[126:127], v23, s[40:43], 0 offen offset:32
    s_nop 0
    v_and_b32 v120, 0xffff0000, v103
    v_lshlrev_b32 v121, 16, v103
    v_pk_mul_f32 v[120:121], v[120:121], v[10:11]
    v_cvt_pk_bf16_f32 v124, v120, v121
    v_lshlrev_b32 v120, 16, v124
    v_and_b32 v121, 0xffff0000, v124
    v_cvt_pk_bf16_f32 v124, v44, v45
    v_lshlrev_b32 v122, 16, v124
    v_and_b32 v123, 0xffff0000, v124
    v_pk_add_f32 v[122:123], v[122:123], v[120:121]
    v_cvt_pk_bf16_f32 v126, v122, v123
    v_and_b32 v120, 0xffff0000, v102
    v_lshlrev_b32 v121, 16, v102
    v_pk_mul_f32 v[120:121], v[120:121], v[10:11]
    v_cvt_pk_bf16_f32 v124, v120, v121
    v_lshlrev_b32 v120, 16, v124
    v_and_b32 v121, 0xffff0000, v124
    v_cvt_pk_bf16_f32 v124, v46, v47
    v_lshlrev_b32 v122, 16, v124
    v_and_b32 v123, 0xffff0000, v124
    v_pk_add_f32 v[122:123], v[122:123], v[120:121]
    v_cvt_pk_bf16_f32 v127, v122, v123
    buffer_store_dwordx2 v[126:127], v23, s[40:43], 0 offen offset:48
    s_nop 0
    v_and_b32 v120, 0xffff0000, v105
    v_lshlrev_b32 v121, 16, v105
    v_pk_mul_f32 v[120:121], v[120:121], v[10:11]
    v_cvt_pk_bf16_f32 v124, v120, v121
    v_lshlrev_b32 v120, 16, v124
    v_and_b32 v121, 0xffff0000, v124
    v_cvt_pk_bf16_f32 v124, v48, v49
    v_lshlrev_b32 v122, 16, v124
    v_and_b32 v123, 0xffff0000, v124
    v_pk_add_f32 v[122:123], v[122:123], v[120:121]
    v_cvt_pk_bf16_f32 v126, v122, v123
    v_and_b32 v120, 0xffff0000, v104
    v_lshlrev_b32 v121, 16, v104
    v_pk_mul_f32 v[120:121], v[120:121], v[10:11]
    v_cvt_pk_bf16_f32 v124, v120, v121
    v_lshlrev_b32 v120, 16, v124
    v_and_b32 v121, 0xffff0000, v124
    v_cvt_pk_bf16_f32 v124, v50, v51
    v_lshlrev_b32 v122, 16, v124
    v_and_b32 v123, 0xffff0000, v124
    v_pk_add_f32 v[122:123], v[122:123], v[120:121]
    v_cvt_pk_bf16_f32 v127, v122, v123
    buffer_store_dwordx2 v[126:127], v23, s[40:43], 0 offen offset:2048
    s_nop 0
    v_and_b32 v120, 0xffff0000, v107
    v_lshlrev_b32 v121, 16, v107
    v_pk_mul_f32 v[120:121], v[120:121], v[10:11]
    v_cvt_pk_bf16_f32 v124, v120, v121
    v_lshlrev_b32 v120, 16, v124
    v_and_b32 v121, 0xffff0000, v124
    v_cvt_pk_bf16_f32 v124, v52, v53
    v_lshlrev_b32 v122, 16, v124
    v_and_b32 v123, 0xffff0000, v124
    v_pk_add_f32 v[122:123], v[122:123], v[120:121]
    v_cvt_pk_bf16_f32 v126, v122, v123
    v_and_b32 v120, 0xffff0000, v106
    v_lshlrev_b32 v121, 16, v106
    v_pk_mul_f32 v[120:121], v[120:121], v[10:11]
    v_cvt_pk_bf16_f32 v124, v120, v121
    v_lshlrev_b32 v120, 16, v124
    v_and_b32 v121, 0xffff0000, v124
    v_cvt_pk_bf16_f32 v124, v54, v55
    v_lshlrev_b32 v122, 16, v124
    v_and_b32 v123, 0xffff0000, v124
    v_pk_add_f32 v[122:123], v[122:123], v[120:121]
    v_cvt_pk_bf16_f32 v127, v122, v123
    buffer_store_dwordx2 v[126:127], v23, s[40:43], 0 offen offset:2064
    s_nop 0
    v_and_b32 v120, 0xffff0000, v109
    v_lshlrev_b32 v121, 16, v109
    v_pk_mul_f32 v[120:121], v[120:121], v[10:11]
    v_cvt_pk_bf16_f32 v124, v120, v121
    v_lshlrev_b32 v120, 16, v124
    v_and_b32 v121, 0xffff0000, v124
    v_cvt_pk_bf16_f32 v124, v56, v57
    v_lshlrev_b32 v122, 16, v124
    v_and_b32 v123, 0xffff0000, v124
    v_pk_add_f32 v[122:123], v[122:123], v[120:121]
    v_cvt_pk_bf16_f32 v126, v122, v123
    v_and_b32 v120, 0xffff0000, v108
    v_lshlrev_b32 v121, 16, v108
    v_pk_mul_f32 v[120:121], v[120:121], v[10:11]
    v_cvt_pk_bf16_f32 v124, v120, v121
    v_lshlrev_b32 v120, 16, v124
    v_and_b32 v121, 0xffff0000, v124
    v_cvt_pk_bf16_f32 v124, v58, v59
    v_lshlrev_b32 v122, 16, v124
    v_and_b32 v123, 0xffff0000, v124
    v_pk_add_f32 v[122:123], v[122:123], v[120:121]
    v_cvt_pk_bf16_f32 v127, v122, v123
    buffer_store_dwordx2 v[126:127], v23, s[40:43], 0 offen offset:2080
    s_nop 0
    v_and_b32 v120, 0xffff0000, v111
    v_lshlrev_b32 v121, 16, v111
    v_pk_mul_f32 v[120:121], v[120:121], v[10:11]
    v_cvt_pk_bf16_f32 v124, v120, v121
    v_lshlrev_b32 v120, 16, v124
    v_and_b32 v121, 0xffff0000, v124
    v_cvt_pk_bf16_f32 v124, v60, v61
    v_lshlrev_b32 v122, 16, v124
    v_and_b32 v123, 0xffff0000, v124
    v_pk_add_f32 v[122:123], v[122:123], v[120:121]
    v_cvt_pk_bf16_f32 v126, v122, v123
    v_and_b32 v120, 0xffff0000, v110
    v_lshlrev_b32 v121, 16, v110
    v_pk_mul_f32 v[120:121], v[120:121], v[10:11]
    v_cvt_pk_bf16_f32 v124, v120, v121
    v_lshlrev_b32 v120, 16, v124
    v_and_b32 v121, 0xffff0000, v124
    v_cvt_pk_bf16_f32 v124, v62, v63
    v_lshlrev_b32 v122, 16, v124
    v_and_b32 v123, 0xffff0000, v124
    v_pk_add_f32 v[122:123], v[122:123], v[120:121]
    v_cvt_pk_bf16_f32 v127, v122, v123
    buffer_store_dwordx2 v[126:127], v23, s[40:43], 0 offen offset:2096
    s_nop 0
    s_branch L_k1_done
L_cv_aux:
    s_waitcnt lgkmcnt(0)
    s_barrier
    s_load_dwordx2 s[6:7], s[0:1], 0
    s_load_dwordx2 s[8:9], s[0:1], 80
    s_load_dwordx2 s[10:11], s[0:1], 72
    s_lshl_b32 s20, s2, 2
    s_sub_u32 s21, s3, 4
    s_add_u32 s20, s20, s21
    v_lshlrev_b32 v2, 4, v1
    s_lshl_b32 s21, s20, 12
    v_add_u32 v3, s21, v2
    s_waitcnt lgkmcnt(0)
    s_mov_b32 s28, s6
    s_mov_b32 s29, s7
    s_mov_b32 s30, 0x200000
    s_mov_b32 s31, 0x00020000
    s_mov_b32 s32, s8
    s_mov_b32 s33, s9
    s_mov_b32 s34, 0x400
    s_mov_b32 s35, 0x00020000
    s_mov_b32 s36, s10
    s_mov_b32 s37, s11
    s_mov_b32 s38, 0x158000
    s_mov_b32 s39, 0x00020000
    s_mov_b32 s40, s4
    s_mov_b32 s41, s5
    s_mov_b32 s42, 0x10000000
    s_mov_b32 s43, 0x00020000
    buffer_load_dwordx4 v[8:11], v2, s[32:35], 0 offen
    buffer_load_dwordx4 v[12:15], v3, s[28:31], 0 offen offset:0
    buffer_load_dwordx4 v[16:19], v3, s[28:31], 0 offen offset:1024
    buffer_load_dwordx4 v[20:23], v3, s[28:31], 0 offen offset:2048
    buffer_load_dwordx4 v[24:27], v3, s[28:31], 0 offen offset:3072
    s_cmp_ge_u32 s20, 176
    s_cbranch_scc1 L_aux_now2a
    s_lshr_b32 s22, s20, 3
    s_and_b32 s23, s20, 7
    v_and_b32 v4, 7, v1
    v_lshrrev_b32 v5, 3, v1
    s_lshl_b32 s24, s22, 6
    v_lshlrev_b32 v5, 3, v5
    v_add_u32 v5, s24, v5
    s_lshl_b32 s24, s23, 6
    v_lshlrev_b32 v4, 3, v4
    v_add_u32 v4, s24, v4
    v_lshlrev_b32 v6, 10, v5
    v_lshl_add_u32 v6, v4, 1, v6
    v_add_u32 v7, 0x1000, v6
    buffer_load_dwordx4 v[64:67], v6, s[36:39], 0 offen offset:0
    buffer_load_dwordx4 v[68:71], v6, s[36:39], 0 offen offset:1024
    buffer_load_dwordx4 v[72:75], v6, s[36:39], 0 offen offset:2048
    buffer_load_dwordx4 v[76:79], v6, s[36:39], 0 offen offset:3072
    buffer_load_dwordx4 v[80:83], v7, s[36:39], 0 offen offset:0
    buffer_load_dwordx4 v[84:87], v7, s[36:39], 0 offen offset:1024
    buffer_load_dwordx4 v[88:91], v7, s[36:39], 0 offen offset:2048
    buffer_load_dwordx4 v[92:95], v7, s[36:39], 0 offen offset:3072
    s_movk_i32 s25, 2816
    v_mul_lo_u32 v6, v4, s25
    v_lshl_add_u32 v6, v5, 1, v6
    v_add_u32 v6, 0x700000, v6
    s_waitcnt vmcnt(8)
    s_branch L_aux_go
L_aux_now2a:
    s_waitcnt vmcnt(0)
L_aux_go:
    v_lshlrev_b32 v32, 16, v8
    v_and_b32 v33, 0xffff0000, v8
    v_lshlrev_b32 v34, 16, v9
    v_and_b32 v35, 0xffff0000, v9
    v_lshlrev_b32 v36, 16, v10
    v_and_b32 v37, 0xffff0000, v10
    v_lshlrev_b32 v38, 16, v11
    v_and_b32 v39, 0xffff0000, v11
    s_mov_b32 s52, 0x3fb8aa3b
    v_lshlrev_b32 v40, 16, v12
    v_and_b32 v41, 0xffff0000, v12
    v_pk_mul_f32 v[42:43], v[40:41], v[32:33]
    v_cvt_pk_bf16_f32 v46, v42, v43
    v_lshlrev_b32 v42, 16, v46
    v_and_b32 v43, 0xffff0000, v46
    v_mov_b32 v44, v42
    v_mov_b32 v45, v43
    v_lshlrev_b32 v40, 16, v13
    v_and_b32 v41, 0xffff0000, v13
    v_pk_mul_f32 v[42:43], v[40:41], v[34:35]
    v_cvt_pk_bf16_f32 v46, v42, v43
    v_lshlrev_b32 v42, 16, v46
    v_and_b32 v43, 0xffff0000, v46
    v_pk_add_f32 v[44:45], v[44:45], v[42:43]
    v_lshlrev_b32 v40, 16, v14
    v_and_b32 v41, 0xffff0000, v14
    v_pk_mul_f32 v[42:43], v[40:41], v[36:37]
    v_cvt_pk_bf16_f32 v46, v42, v43
    v_lshlrev_b32 v42, 16, v46
    v_and_b32 v43, 0xffff0000, v46
    v_pk_add_f32 v[44:45], v[44:45], v[42:43]
    v_lshlrev_b32 v40, 16, v15
    v_and_b32 v41, 0xffff0000, v15
    v_pk_mul_f32 v[42:43], v[40:41], v[38:39]
    v_cvt_pk_bf16_f32 v46, v42, v43
    v_lshlrev_b32 v42, 16, v46
    v_and_b32 v43, 0xffff0000, v46
    v_pk_add_f32 v[44:45], v[44:45], v[42:43]
    v_add_f32 v44, v44, v45
    s_nop 1
    v_add_f32_dpp v44, v44, v44 quad_perm:[1,0,3,2] row_mask:0xf bank_mask:0xf
    s_nop 1
    v_add_f32_dpp v44, v44, v44 quad_perm:[2,3,0,1] row_mask:0xf bank_mask:0xf
    s_nop 1
    v_add_f32_dpp v44, v44, v44 row_half_mirror row_mask:0xf bank_mask:0xf
    s_nop 1
    v_add_f32_dpp v44, v44, v44 row_mirror row_mask:0xf bank_mask:0xf
    s_nop 1
    v_readlane_b32 s56, v44, 0
    v_readlane_b32 s57, v44, 16
    v_readlane_b32 s58, v44, 32
    v_readlane_b32 s59, v44, 48
    s_nop 1
    v_mov_b32 v46, s56
    v_add_f32 v46, s57, v46
    v_add_f32 v46, s58, v46
    v_add_f32 v46, s59, v46
    v_cvt_pk_bf16_f32 v46, v46, v46
    v_lshlrev_b32 v46, 16, v46
    v_mul_f32 v46, s52, v46
    v_exp_f32 v46, -v46
    s_nop 0
    v_add_f32 v46, 1.0, v46
    v_rcp_f32 v46, v46
    s_nop 0
    v_cvt_pk_bf16_f32 v46, v46, v46
    v_lshlrev_b32 v46, 16, v46
    v_mov_b32 v48, v46
    v_lshlrev_b32 v40, 16, v16
    v_and_b32 v41, 0xffff0000, v16
    v_pk_mul_f32 v[42:43], v[40:41], v[32:33]
    v_cvt_pk_bf16_f32 v46, v42, v43
    v_lshlrev_b32 v42, 16, v46
    v_and_b32 v43, 0xffff0000, v46
    v_mov_b32 v44, v42
    v_mov_b32 v45, v43
    v_lshlrev_b32 v40, 16, v17
    v_and_b32 v41, 0xffff0000, v17
    v_pk_mul_f32 v[42:43], v[40:41], v[34:35]
    v_cvt_pk_bf16_f32 v46, v42, v43
    v_lshlrev_b32 v42, 16, v46
    v_and_b32 v43, 0xffff0000, v46
    v_pk_add_f32 v[44:45], v[44:45], v[42:43]
    v_lshlrev_b32 v40, 16, v18
    v_and_b32 v41, 0xffff0000, v18
    v_pk_mul_f32 v[42:43], v[40:41], v[36:37]
    v_cvt_pk_bf16_f32 v46, v42, v43
    v_lshlrev_b32 v42, 16, v46
    v_and_b32 v43, 0xffff0000, v46
    v_pk_add_f32 v[44:45], v[44:45], v[42:43]
    v_lshlrev_b32 v40, 16, v19
    v_and_b32 v41, 0xffff0000, v19
    v_pk_mul_f32 v[42:43], v[40:41], v[38:39]
    v_cvt_pk_bf16_f32 v46, v42, v43
    v_lshlrev_b32 v42, 16, v46
    v_and_b32 v43, 0xffff0000, v46
    v_pk_add_f32 v[44:45], v[44:45], v[42:43]
    v_add_f32 v44, v44, v45
    s_nop 1
    v_add_f32_dpp v44, v44, v44 quad_perm:[1,0,3,2] row_mask:0xf bank_mask:0xf
    s_nop 1
    v_add_f32_dpp v44, v44, v44 quad_perm:[2,3,0,1] row_mask:0xf bank_mask:0xf
    s_nop 1
    v_add_f32_dpp v44, v44, v44 row_half_mirror row_mask:0xf bank_mask:0xf
    s_nop 1
    v_add_f32_dpp v44, v44, v44 row_mirror row_mask:0xf bank_mask:0xf
    s_nop 1
    v_readlane_b32 s56, v44, 0
    v_readlane_b32 s57, v44, 16
    v_readlane_b32 s58, v44, 32
    v_readlane_b32 s59, v44, 48
    s_nop 1
    v_mov_b32 v46, s56
    v_add_f32 v46, s57, v46
    v_add_f32 v46, s58, v46
    v_add_f32 v46, s59, v46
    v_cvt_pk_bf16_f32 v46, v46, v46
    v_lshlrev_b32 v46, 16, v46
    v_mul_f32 v46, s52, v46
    v_exp_f32 v46, -v46
    s_nop 0
    v_add_f32 v46, 1.0, v46
    v_rcp_f32 v46, v46
    s_nop 0
    v_cvt_pk_bf16_f32 v46, v46, v46
    v_lshlrev_b32 v46, 16, v46
    v_mov_b32 v49, v46
    v_lshlrev_b32 v40, 16, v20
    v_and_b32 v41, 0xffff0000, v20
    v_pk_mul_f32 v[42:43], v[40:41], v[32:33]
    v_cvt_pk_bf16_f32 v46, v42, v43
    v_lshlrev_b32 v42, 16, v46
    v_and_b32 v43, 0xffff0000, v46
    v_mov_b32 v44, v42
    v_mov_b32 v45, v43
    v_lshlrev_b32 v40, 16, v21
    v_and_b32 v41, 0xffff0000, v21
    v_pk_mul_f32 v[42:43], v[40:41], v[34:35]
    v_cvt_pk_bf16_f32 v46, v42, v43
    v_lshlrev_b32 v42, 16, v46
    v_and_b32 v43, 0xffff0000, v46
    v_pk_add_f32 v[44:45], v[44:45], v[42:43]
    v_lshlrev_b32 v40, 16, v22
    v_and_b32 v41, 0xffff0000, v22
    v_pk_mul_f32 v[42:43], v[40:41], v[36:37]
    v_cvt_pk_bf16_f32 v46, v42, v43
    v_lshlrev_b32 v42, 16, v46
    v_and_b32 v43, 0xffff0000, v46
    v_pk_add_f32 v[44:45], v[44:45], v[42:43]
    v_lshlrev_b32 v40, 16, v23
    v_and_b32 v41, 0xffff0000, v23
    v_pk_mul_f32 v[42:43], v[40:41], v[38:39]
    v_cvt_pk_bf16_f32 v46, v42, v43
    v_lshlrev_b32 v42, 16, v46
    v_and_b32 v43, 0xffff0000, v46
    v_pk_add_f32 v[44:45], v[44:45], v[42:43]
    v_add_f32 v44, v44, v45
    s_nop 1
    v_add_f32_dpp v44, v44, v44 quad_perm:[1,0,3,2] row_mask:0xf bank_mask:0xf
    s_nop 1
    v_add_f32_dpp v44, v44, v44 quad_perm:[2,3,0,1] row_mask:0xf bank_mask:0xf
    s_nop 1
    v_add_f32_dpp v44, v44, v44 row_half_mirror row_mask:0xf bank_mask:0xf
    s_nop 1
    v_add_f32_dpp v44, v44, v44 row_mirror row_mask:0xf bank_mask:0xf
    s_nop 1
    v_readlane_b32 s56, v44, 0
    v_readlane_b32 s57, v44, 16
    v_readlane_b32 s58, v44, 32
    v_readlane_b32 s59, v44, 48
    s_nop 1
    v_mov_b32 v46, s56
    v_add_f32 v46, s57, v46
    v_add_f32 v46, s58, v46
    v_add_f32 v46, s59, v46
    v_cvt_pk_bf16_f32 v46, v46, v46
    v_lshlrev_b32 v46, 16, v46
    v_mul_f32 v46, s52, v46
    v_exp_f32 v46, -v46
    s_nop 0
    v_add_f32 v46, 1.0, v46
    v_rcp_f32 v46, v46
    s_nop 0
    v_cvt_pk_bf16_f32 v46, v46, v46
    v_lshlrev_b32 v46, 16, v46
    v_mov_b32 v50, v46
    v_lshlrev_b32 v40, 16, v24
    v_and_b32 v41, 0xffff0000, v24
    v_pk_mul_f32 v[42:43], v[40:41], v[32:33]
    v_cvt_pk_bf16_f32 v46, v42, v43
    v_lshlrev_b32 v42, 16, v46
    v_and_b32 v43, 0xffff0000, v46
    v_mov_b32 v44, v42
    v_mov_b32 v45, v43
    v_lshlrev_b32 v40, 16, v25
    v_and_b32 v41, 0xffff0000, v25
    v_pk_mul_f32 v[42:43], v[40:41], v[34:35]
    v_cvt_pk_bf16_f32 v46, v42, v43
    v_lshlrev_b32 v42, 16, v46
    v_and_b32 v43, 0xffff0000, v46
    v_pk_add_f32 v[44:45], v[44:45], v[42:43]
    v_lshlrev_b32 v40, 16, v26
    v_and_b32 v41, 0xffff0000, v26
    v_pk_mul_f32 v[42:43], v[40:41], v[36:37]
    v_cvt_pk_bf16_f32 v46, v42, v43
    v_lshlrev_b32 v42, 16, v46
    v_and_b32 v43, 0xffff0000, v46
    v_pk_add_f32 v[44:45], v[44:45], v[42:43]
    v_lshlrev_b32 v40, 16, v27
    v_and_b32 v41, 0xffff0000, v27
    v_pk_mul_f32 v[42:43], v[40:41], v[38:39]
    v_cvt_pk_bf16_f32 v46, v42, v43
    v_lshlrev_b32 v42, 16, v46
    v_and_b32 v43, 0xffff0000, v46
    v_pk_add_f32 v[44:45], v[44:45], v[42:43]
    v_add_f32 v44, v44, v45
    s_nop 1
    v_add_f32_dpp v44, v44, v44 quad_perm:[1,0,3,2] row_mask:0xf bank_mask:0xf
    s_nop 1
    v_add_f32_dpp v44, v44, v44 quad_perm:[2,3,0,1] row_mask:0xf bank_mask:0xf
    s_nop 1
    v_add_f32_dpp v44, v44, v44 row_half_mirror row_mask:0xf bank_mask:0xf
    s_nop 1
    v_add_f32_dpp v44, v44, v44 row_mirror row_mask:0xf bank_mask:0xf
    s_nop 1
    v_readlane_b32 s56, v44, 0
    v_readlane_b32 s57, v44, 16
    v_readlane_b32 s58, v44, 32
    v_readlane_b32 s59, v44, 48
    s_nop 1
    v_mov_b32 v46, s56
    v_add_f32 v46, s57, v46
    v_add_f32 v46, s58, v46
    v_add_f32 v46, s59, v46
    v_cvt_pk_bf16_f32 v46, v46, v46
    v_lshlrev_b32 v46, 16, v46
    v_mul_f32 v46, s52, v46
    v_exp_f32 v46, -v46
    s_nop 0
    v_add_f32 v46, 1.0, v46
    v_rcp_f32 v46, v46
    s_nop 0
    v_cvt_pk_bf16_f32 v46, v46, v46
    v_lshlrev_b32 v46, 16, v46
    v_mov_b32 v51, v46
    s_lshl_b32 s21, s20, 4
    s_add_u32 s21, s21, 4194304
    v_mov_b32 v2, s21
    v_cmp_eq_u32 vcc, 0, v1
    s_and_saveexec_b64 s[54:55], vcc
    buffer_store_dwordx4 v[48:51], v2, s[40:43], 0 offen
    s_mov_b64 exec, s[54:55]
    s_cmp_ge_u32 s20, 176
    s_cbranch_scc1 L_aux_done
    s_mov_b32 s44, 0x05040100
    s_mov_b32 s45, 0x07060302
    s_movk_i32 s27, 2816
    s_waitcnt vmcnt(0)
    v_perm_b32 v100, v68, v64, s44
    v_perm_b32 v101, v76, v72, s44
    v_perm_b32 v102, v84, v80, s44
    v_perm_b32 v103, v92, v88, s44
    buffer_store_dwordx4 v[100:103], v6, s[40:43], 0 offen
    v_add_u32 v6, s27, v6
    s_nop 1
    v_perm_b32 v100, v68, v64, s45
    v_perm_b32 v101, v76, v72, s45
    v_perm_b32 v102, v84, v80, s45
    v_perm_b32 v103, v92, v88, s45
    buffer_store_dwordx4 v[100:103], v6, s[40:43], 0 offen
    v_add_u32 v6, s27, v6
    s_nop 1
    v_perm_b32 v100, v69, v65, s44
    v_perm_b32 v101, v77, v73, s44
    v_perm_b32 v102, v85, v81, s44
    v_perm_b32 v103, v93, v89, s44
    buffer_store_dwordx4 v[100:103], v6, s[40:43], 0 offen
    v_add_u32 v6, s27, v6
    s_nop 1
    v_perm_b32 v100, v69, v65, s45
    v_perm_b32 v101, v77, v73, s45
    v_perm_b32 v102, v85, v81, s45
    v_perm_b32 v103, v93, v89, s45
    buffer_store_dwordx4 v[100:103], v6, s[40:43], 0 offen
    v_add_u32 v6, s27, v6
    s_nop 1
    v_perm_b32 v100, v70, v66, s44
    v_perm_b32 v101, v78, v74, s44
    v_perm_b32 v102, v86, v82, s44
    v_perm_b32 v103, v94, v90, s44
    buffer_store_dwordx4 v[100:103], v6, s[40:43], 0 offen
    v_add_u32 v6, s27, v6
    s_nop 1
    v_perm_b32 v100, v70, v66, s45
    v_perm_b32 v101, v78, v74, s45
    v_perm_b32 v102, v86, v82, s45
    v_perm_b32 v103, v94, v90, s45
    buffer_store_dwordx4 v[100:103], v6, s[40:43], 0 offen
    v_add_u32 v6, s27, v6
    s_nop 1
    v_perm_b32 v100, v71, v67, s44
    v_perm_b32 v101, v79, v75, s44
    v_perm_b32 v102, v87, v83, s44
    v_perm_b32 v103, v95, v91, s44
    buffer_store_dwordx4 v[100:103], v6, s[40:43], 0 offen
    v_add_u32 v6, s27, v6
    s_nop 1
    v_perm_b32 v100, v71, v67, s45
    v_perm_b32 v101, v79, v75, s45
    v_perm_b32 v102, v87, v83, s45
    v_perm_b32 v103, v95, v91, s45
    buffer_store_dwordx4 v[100:103], v6, s[40:43], 0 offen
    s_nop 1
L_aux_done:
    s_branch L_k1_done
L_k1_gemm1:
    s_load_dwordx2 s[6:7], s[0:1], 0
    s_load_dwordx2 s[8:9], s[0:1], 64
    s_load_dwordx2 s[10:11], s[0:1], 56
    s_sub_u32 s20, s2, 128
    s_and_b32 s21, s20, 7
    s_lshl_b32 s21, s21, 1
    s_lshr_b32 s22, s20, 3
    s_and_b32 s45, s22, 1
    s_add_u32 s21, s21, s45
    s_lshr_b32 s22, s20, 4
    s_mul_i32 s23, s22, 192
    s_lshl_b32 s24, s21, 7
    s_lshr_b32 s25, s3, 2
    s_and_b32 s26, s3, 3
    v_and_b32 v2, 31, v1
    v_lshrrev_b32 v3, 5, v1
    v_lshrrev_b32 v4, 3, v0
    v_and_b32 v5, 7, v0
    v_lshlrev_b32 v6, 4, v5
    s_waitcnt lgkmcnt(0)
    s_mov_b32 s28, s6
    s_mov_b32 s29, s7
    s_mov_b32 s30, 0x200000
    s_mov_b32 s31, 0x00020000
    s_mov_b32 s32, s8
    s_mov_b32 s33, s9
    s_mov_b32 s34, 0xac0
    s_mov_b32 s35, 0x00020000
    s_mov_b32 s36, s10
    s_mov_b32 s37, s11
    s_mov_b32 s38, 0x158000
    s_mov_b32 s39, 0x00020000
    s_mov_b32 s40, s4
    s_mov_b32 s41, s5
    s_mov_b32 s42, 0x10000000
    s_mov_b32 s43, 0x00020000
    s_movk_i32 s44, 2731
    s_movk_i32 s46, 2752
    s_lshl_b32 s47, s23, 1
    v_add_u32 v7, 0, v0
    v_mul_lo_u32 v19, v7, s44
    v_lshrrev_b32 v19, 16, v19
    v_mul_u32_u24 v17, 24, v19
    v_sub_u32 v17, v7, v17
    v_mul_lo_u32 v8, v19, s46
    v_lshl_add_u32 v8, v17, 4, v8
    v_add_u32 v8, s47, v8
    v_mul_u32_u24 v19, 448, v19
    v_lshl_add_u32 v180, v17, 4, v19
    v_add_u32 v7, 512, v0
    v_mul_lo_u32 v19, v7, s44
    v_lshrrev_b32 v19, 16, v19
    v_mul_u32_u24 v17, 24, v19
    v_sub_u32 v17, v7, v17
    v_mul_lo_u32 v9, v19, s46
    v_lshl_add_u32 v9, v17, 4, v9
    v_add_u32 v9, s47, v9
    v_mul_u32_u24 v19, 448, v19
    v_lshl_add_u32 v181, v17, 4, v19
    v_add_u32 v7, 1024, v0
    v_mul_lo_u32 v19, v7, s44
    v_lshrrev_b32 v19, 16, v19
    v_mul_u32_u24 v17, 24, v19
    v_sub_u32 v17, v7, v17
    v_mul_lo_u32 v10, v19, s46
    v_lshl_add_u32 v10, v17, 4, v10
    v_add_u32 v10, s47, v10
    v_mul_u32_u24 v19, 448, v19
    v_lshl_add_u32 v182, v17, 4, v19
    v_add_u32 v7, s24, v4
    v_lshlrev_b32 v7, 10, v7
    v_add_u32 v11, v7, v6
    v_add_u32 v12, 0x10000, v11
    v_mul_u32_u24 v13, 144, v4
    v_add_u32 v13, v13, v6
    v_add_u32 v13, 28672, v13
    v_and_b32 v7, 15, v1
    v_lshrrev_b32 v14, 2, v7
    v_lshl_add_u32 v14, v3, 3, v14
    v_mul_u32_u24 v14, 448, v14
    v_and_b32 v7, 3, v7
    v_lshlrev_b32 v7, 3, v7
    v_add_u32 v14, v14, v7
    v_lshrrev_b32 v7, 4, v1
    v_and_b32 v7, 1, v7
    v_lshl_add_u32 v14, v7, 5, v14
    s_mul_i32 s27, s25, 192
    v_add_u32 v14, s27, v14
    s_lshl_b32 s27, s26, 5
    v_add_u32 v15, s27, v2
    v_mul_u32_u24 v15, 144, v15
    v_lshlrev_b32 v7, 4, v3
    v_add_u32 v15, v15, v7
    v_add_u32 v15, 28672, v15
    s_add_u32 s27, s24, s27
    v_add_u32 v16, s27, v2
    s_movk_i32 s44, 2816
    v_mul_lo_u32 v16, v16, s44
    s_mul_i32 s45, s25, 96
    s_add_u32 s45, s45, s23
    v_lshlrev_b32 v7, 2, v3
    v_add_u32 v7, s45, v7
    v_lshlrev_b32 v17, 1, v7
    v_add_u32 v16, v16, v17
    v_add_u32 v16, 0x900000, v16
    buffer_load_dwordx2 v[20:21], v17, s[32:35], 0 offen offset:0
    buffer_load_dwordx2 v[22:23], v17, s[32:35], 0 offen offset:16
    buffer_load_dwordx2 v[24:25], v17, s[32:35], 0 offen offset:32
    buffer_load_dwordx2 v[26:27], v17, s[32:35], 0 offen offset:48
    buffer_load_dwordx2 v[28:29], v17, s[32:35], 0 offen offset:64
    buffer_load_dwordx2 v[30:31], v17, s[32:35], 0 offen offset:80
    buffer_load_dwordx2 v[32:33], v17, s[32:35], 0 offen offset:96
    buffer_load_dwordx2 v[34:35], v17, s[32:35], 0 offen offset:112
    buffer_load_dwordx2 v[36:37], v17, s[32:35], 0 offen offset:128
    buffer_load_dwordx2 v[38:39], v17, s[32:35], 0 offen offset:144
    buffer_load_dwordx2 v[40:41], v17, s[32:35], 0 offen offset:160
    buffer_load_dwordx2 v[42:43], v17, s[32:35], 0 offen offset:176
    v_mov_b32 v190, v180
    v_mov_b32 v191, v181
    v_mov_b32 v192, v182
    v_add_u32 v184, 0, v14
    v_add_u32 v187, 0, v15
    v_add_u32 v185, 47104, v14
    v_add_u32 v188, 47104, v15
    v_add_u32 v186, 94208, v14
    v_add_u32 v189, 94208, v15
    v_mov_b32 v136, 0
    v_mov_b32 v137, 0
    v_mov_b32 v138, 0
    v_mov_b32 v139, 0
    v_mov_b32 v140, 0
    v_mov_b32 v141, 0
    v_mov_b32 v142, 0
    v_mov_b32 v143, 0
    v_mov_b32 v144, 0
    v_mov_b32 v145, 0
    v_mov_b32 v146, 0
    v_mov_b32 v147, 0
    v_mov_b32 v148, 0
    v_mov_b32 v149, 0
    v_mov_b32 v150, 0
    v_mov_b32 v151, 0
    v_mov_b32 v152, 0
    v_mov_b32 v153, 0
    v_mov_b32 v154, 0
    v_mov_b32 v155, 0
    v_mov_b32 v156, 0
    v_mov_b32 v157, 0
    v_mov_b32 v158, 0
    v_mov_b32 v159, 0
    v_mov_b32 v160, 0
    v_mov_b32 v161, 0
    v_mov_b32 v162, 0
    v_mov_b32 v163, 0
    v_mov_b32 v164, 0
    v_mov_b32 v165, 0
    v_mov_b32 v166, 0
    v_mov_b32 v167, 0
    v_mov_b32 v168, 0
    v_mov_b32 v169, 0
    v_mov_b32 v170, 0
    v_mov_b32 v171, 0
    v_mov_b32 v172, 0
    v_mov_b32 v173, 0
    v_mov_b32 v174, 0
    v_mov_b32 v175, 0
    v_mov_b32 v176, 0
    v_mov_b32 v177, 0
    v_mov_b32 v178, 0
    v_mov_b32 v179, 0
    v_mov_b32 v180, 0
    v_mov_b32 v181, 0
    v_mov_b32 v182, 0
    v_mov_b32 v183, 0
    s_mov_b32 s48, 0
    buffer_load_dwordx4 v[44:47], v8, s[36:39], s48 offen
    buffer_load_dwordx4 v[48:51], v9, s[36:39], s48 offen
    buffer_load_dwordx4 v[52:55], v10, s[36:39], s48 offen
    buffer_load_dwordx4 v[56:59], v11, s[28:31], 0 offen offset:0
    buffer_load_dwordx4 v[60:63], v12, s[28:31], 0 offen offset:0
    s_mov_b32 s48, 176128
    buffer_load_dwordx4 v[64:67], v8, s[36:39], s48 offen
    buffer_load_dwordx4 v[68:71], v9, s[36:39], s48 offen
    buffer_load_dwordx4 v[72:75], v10, s[36:39], s48 offen
    buffer_load_dwordx4 v[76:79], v11, s[28:31], 0 offen offset:128
    buffer_load_dwordx4 v[80:83], v12, s[28:31], 0 offen offset:128
    s_mov_b32 s48, 352256
    buffer_load_dwordx4 v[84:87], v8, s[36:39], s48 offen
    buffer_load_dwordx4 v[88:91], v9, s[36:39], s48 offen
    buffer_load_dwordx4 v[92:95], v10, s[36:39], s48 offen
    buffer_load_dwordx4 v[96:99], v11, s[28:31], 0 offen offset:256
    buffer_load_dwordx4 v[100:103], v12, s[28:31], 0 offen offset:256
    s_waitcnt vmcnt(10)
    ds_write_b128 v190, v[44:47] offset:0
    ds_write_b128 v191, v[48:51] offset:0
    ds_write_b128 v192, v[52:55] offset:0
    ds_write_b128 v13, v[56:59] offset:0
    ds_write_b128 v13, v[60:63] offset:9216
    s_mov_b32 s48, 528384
    buffer_load_dwordx4 v[44:47], v8, s[36:39], s48 offen
    buffer_load_dwordx4 v[48:51], v9, s[36:39], s48 offen
    buffer_load_dwordx4 v[52:55], v10, s[36:39], s48 offen
    buffer_load_dwordx4 v[56:59], v11, s[28:31], 0 offen offset:384
    buffer_load_dwordx4 v[60:63], v12, s[28:31], 0 offen offset:384
    s_waitcnt vmcnt(10)
    ds_write_b128 v190, v[64:67] offset:47104
    ds_write_b128 v191, v[68:71] offset:47104
    ds_write_b128 v192, v[72:75] offset:47104
    ds_write_b128 v13, v[76:79] offset:47104
    ds_write_b128 v13, v[80:83] offset:56320
    s_mov_b32 s48, 704512
    buffer_load_dwordx4 v[64:67], v8, s[36:39], s48 offen
    buffer_load_dwordx4 v[68:71], v9, s[36:39], s48 offen
    buffer_load_dwordx4 v[72:75], v10, s[36:39], s48 offen
    buffer_load_dwordx4 v[76:79], v11, s[28:31], 0 offen offset:512
    buffer_load_dwordx4 v[80:83], v12, s[28:31], 0 offen offset:512
    s_waitcnt lgkmcnt(0)
    s_barrier
    ds_read_b64_tr_b16 v[104:105], v184 offset:0
    ds_read_b64_tr_b16 v[106:107], v184 offset:1792
    ds_read_b64_tr_b16 v[108:109], v184 offset:64
    ds_read_b64_tr_b16 v[110:111], v184 offset:1856
    ds_read_b64_tr_b16 v[112:113], v184 offset:128
    ds_read_b64_tr_b16 v[114:115], v184 offset:1920
    ds_read_b128 v[116:119], v187 offset:0
    s_waitcnt vmcnt(10)
    v_add_u32 v19, 94208, v190
    ds_write_b128 v19, v[84:87]
    v_add_u32 v19, 94208, v191
    ds_write_b128 v19, v[88:91]
    v_add_u32 v19, 94208, v192
    ds_write_b128 v19, v[92:95]
    v_add_u32 v19, 94208, v13
    ds_write_b128 v19, v[96:99]
    v_add_u32 v19, 103424, v13
    ds_write_b128 v19, v[100:103]
    s_mov_b32 s48, 880640
    buffer_load_dwordx4 v[84:87], v8, s[36:39], s48 offen
    buffer_load_dwordx4 v[88:91], v9, s[36:39], s48 offen
    buffer_load_dwordx4 v[92:95], v10, s[36:39], s48 offen
    buffer_load_dwordx4 v[96:99], v11, s[28:31], 0 offen offset:640
    buffer_load_dwordx4 v[100:103], v12, s[28:31], 0 offen offset:640
    ds_read_b64_tr_b16 v[120:121], v184 offset:7168
    ds_read_b64_tr_b16 v[122:123], v184 offset:8960
    ds_read_b64_tr_b16 v[124:125], v184 offset:7232
    ds_read_b64_tr_b16 v[126:127], v184 offset:9024
    ds_read_b64_tr_b16 v[128:129], v184 offset:7296
    ds_read_b64_tr_b16 v[130:131], v184 offset:9088
    ds_read_b128 v[132:135], v187 offset:32
    s_waitcnt lgkmcnt(7)
    v_mfma_f32_32x32x16_bf16 v[136:151], v[104:107], v[116:119], v[136:151]
    v_mfma_f32_32x32x16_bf16 v[152:167], v[108:111], v[116:119], v[152:167]
    v_mfma_f32_32x32x16_bf16 v[168:183], v[112:115], v[116:119], v[168:183]
    ds_read_b64_tr_b16 v[104:105], v184 offset:14336
    ds_read_b64_tr_b16 v[106:107], v184 offset:16128
    ds_read_b64_tr_b16 v[108:109], v184 offset:14400
    ds_read_b64_tr_b16 v[110:111], v184 offset:16192
    ds_read_b64_tr_b16 v[112:113], v184 offset:14464
    ds_read_b64_tr_b16 v[114:115], v184 offset:16256
    ds_read_b128 v[116:119], v187 offset:64
    s_waitcnt lgkmcnt(7)
    v_mfma_f32_32x32x16_bf16 v[136:151], v[120:123], v[132:135], v[136:151]
    v_mfma_f32_32x32x16_bf16 v[152:167], v[124:127], v[132:135], v[152:167]
    v_mfma_f32_32x32x16_bf16 v[168:183], v[128:131], v[132:135], v[168:183]
    ds_read_b64_tr_b16 v[120:121], v184 offset:21504
    ds_read_b64_tr_b16 v[122:123], v184 offset:23296
    ds_read_b64_tr_b16 v[124:125], v184 offset:21568
    ds_read_b64_tr_b16 v[126:127], v184 offset:23360
    ds_read_b64_tr_b16 v[128:129], v184 offset:21632
    ds_read_b64_tr_b16 v[130:131], v184 offset:23424
    ds_read_b128 v[132:135], v187 offset:96
    s_waitcnt lgkmcnt(7)
    v_mfma_f32_32x32x16_bf16 v[136:151], v[104:107], v[116:119], v[136:151]
    v_mfma_f32_32x32x16_bf16 v[152:167], v[108:111], v[116:119], v[152:167]
    v_mfma_f32_32x32x16_bf16 v[168:183], v[112:115], v[116:119], v[168:183]
    ds_read_b64_tr_b16 v[104:105], v185 offset:0
    ds_read_b64_tr_b16 v[106:107], v185 offset:1792
    ds_read_b64_tr_b16 v[108:109], v185 offset:64
    ds_read_b64_tr_b16 v[110:111], v185 offset:1856
    ds_read_b64_tr_b16 v[112:113], v185 offset:128
    ds_read_b64_tr_b16 v[114:115], v185 offset:1920
    ds_read_b128 v[116:119], v188 offset:0
    s_waitcnt lgkmcnt(7)
    v_mfma_f32_32x32x16_bf16 v[136:151], v[120:123], v[132:135], v[136:151]
    v_mfma_f32_32x32x16_bf16 v[152:167], v[124:127], v[132:135], v[152:167]
    v_mfma_f32_32x32x16_bf16 v[168:183], v[128:131], v[132:135], v[168:183]
    s_barrier
    s_waitcnt vmcnt(10)
    ds_write_b128 v190, v[44:47] offset:0
    ds_write_b128 v191, v[48:51] offset:0
    ds_write_b128 v192, v[52:55] offset:0
    ds_write_b128 v13, v[56:59] offset:0
    ds_write_b128 v13, v[60:63] offset:9216
    s_mov_b32 s48, 1056768
    buffer_load_dwordx4 v[44:47], v8, s[36:39], s48 offen
    buffer_load_dwordx4 v[48:51], v9, s[36:39], s48 offen
    buffer_load_dwordx4 v[52:55], v10, s[36:39], s48 offen
    buffer_load_dwordx4 v[56:59], v11, s[28:31], 0 offen offset:768
    buffer_load_dwordx4 v[60:63], v12, s[28:31], 0 offen offset:768
    ds_read_b64_tr_b16 v[120:121], v185 offset:7168
    ds_read_b64_tr_b16 v[122:123], v185 offset:8960
    ds_read_b64_tr_b16 v[124:125], v185 offset:7232
    ds_read_b64_tr_b16 v[126:127], v185 offset:9024
    ds_read_b64_tr_b16 v[128:129], v185 offset:7296
    ds_read_b64_tr_b16 v[130:131], v185 offset:9088
    ds_read_b128 v[132:135], v188 offset:32
    s_waitcnt lgkmcnt(7)
    v_mfma_f32_32x32x16_bf16 v[136:151], v[104:107], v[116:119], v[136:151]
    v_mfma_f32_32x32x16_bf16 v[152:167], v[108:111], v[116:119], v[152:167]
    v_mfma_f32_32x32x16_bf16 v[168:183], v[112:115], v[116:119], v[168:183]
    ds_read_b64_tr_b16 v[104:105], v185 offset:14336
    ds_read_b64_tr_b16 v[106:107], v185 offset:16128
    ds_read_b64_tr_b16 v[108:109], v185 offset:14400
    ds_read_b64_tr_b16 v[110:111], v185 offset:16192
    ds_read_b64_tr_b16 v[112:113], v185 offset:14464
    ds_read_b64_tr_b16 v[114:115], v185 offset:16256
    ds_read_b128 v[116:119], v188 offset:64
    s_waitcnt lgkmcnt(7)
    v_mfma_f32_32x32x16_bf16 v[136:151], v[120:123], v[132:135], v[136:151]
    v_mfma_f32_32x32x16_bf16 v[152:167], v[124:127], v[132:135], v[152:167]
    v_mfma_f32_32x32x16_bf16 v[168:183], v[128:131], v[132:135], v[168:183]
    ds_read_b64_tr_b16 v[120:121], v185 offset:21504
    ds_read_b64_tr_b16 v[122:123], v185 offset:23296
    ds_read_b64_tr_b16 v[124:125], v185 offset:21568
    ds_read_b64_tr_b16 v[126:127], v185 offset:23360
    ds_read_b64_tr_b16 v[128:129], v185 offset:21632
    ds_read_b64_tr_b16 v[130:131], v185 offset:23424
    ds_read_b128 v[132:135], v188 offset:96
    s_waitcnt lgkmcnt(7)
    v_mfma_f32_32x32x16_bf16 v[136:151], v[104:107], v[116:119], v[136:151]
    v_mfma_f32_32x32x16_bf16 v[152:167], v[108:111], v[116:119], v[152:167]
    v_mfma_f32_32x32x16_bf16 v[168:183], v[112:115], v[116:119], v[168:183]
    ds_read_b64_tr_b16 v[104:105], v186 offset:0
    ds_read_b64_tr_b16 v[106:107], v186 offset:1792
    ds_read_b64_tr_b16 v[108:109], v186 offset:64
    ds_read_b64_tr_b16 v[110:111], v186 offset:1856
    ds_read_b64_tr_b16 v[112:113], v186 offset:128
    ds_read_b64_tr_b16 v[114:115], v186 offset:1920
    ds_read_b128 v[116:119], v189 offset:0
    s_waitcnt lgkmcnt(7)
    v_mfma_f32_32x32x16_bf16 v[136:151], v[120:123], v[132:135], v[136:151]
    v_mfma_f32_32x32x16_bf16 v[152:167], v[124:127], v[132:135], v[152:167]
    v_mfma_f32_32x32x16_bf16 v[168:183], v[128:131], v[132:135], v[168:183]
    s_barrier
    s_waitcnt vmcnt(10)
    ds_write_b128 v190, v[64:67] offset:47104
    ds_write_b128 v191, v[68:71] offset:47104
    ds_write_b128 v192, v[72:75] offset:47104
    ds_write_b128 v13, v[76:79] offset:47104
    ds_write_b128 v13, v[80:83] offset:56320
    s_mov_b32 s48, 1232896
    buffer_load_dwordx4 v[64:67], v8, s[36:39], s48 offen
    buffer_load_dwordx4 v[68:71], v9, s[36:39], s48 offen
    buffer_load_dwordx4 v[72:75], v10, s[36:39], s48 offen
    buffer_load_dwordx4 v[76:79], v11, s[28:31], 0 offen offset:896
    buffer_load_dwordx4 v[80:83], v12, s[28:31], 0 offen offset:896
    ds_read_b64_tr_b16 v[120:121], v186 offset:7168
    ds_read_b64_tr_b16 v[122:123], v186 offset:8960
    ds_read_b64_tr_b16 v[124:125], v186 offset:7232
    ds_read_b64_tr_b16 v[126:127], v186 offset:9024
    ds_read_b64_tr_b16 v[128:129], v186 offset:7296
    ds_read_b64_tr_b16 v[130:131], v186 offset:9088
    ds_read_b128 v[132:135], v189 offset:32
    s_waitcnt lgkmcnt(7)
    v_mfma_f32_32x32x16_bf16 v[136:151], v[104:107], v[116:119], v[136:151]
    v_mfma_f32_32x32x16_bf16 v[152:167], v[108:111], v[116:119], v[152:167]
    v_mfma_f32_32x32x16_bf16 v[168:183], v[112:115], v[116:119], v[168:183]
    ds_read_b64_tr_b16 v[104:105], v186 offset:14336
    ds_read_b64_tr_b16 v[106:107], v186 offset:16128
    ds_read_b64_tr_b16 v[108:109], v186 offset:14400
    ds_read_b64_tr_b16 v[110:111], v186 offset:16192
    ds_read_b64_tr_b16 v[112:113], v186 offset:14464
    ds_read_b64_tr_b16 v[114:115], v186 offset:16256
    ds_read_b128 v[116:119], v189 offset:64
    s_waitcnt lgkmcnt(7)
    v_mfma_f32_32x32x16_bf16 v[136:151], v[120:123], v[132:135], v[136:151]
    v_mfma_f32_32x32x16_bf16 v[152:167], v[124:127], v[132:135], v[152:167]
    v_mfma_f32_32x32x16_bf16 v[168:183], v[128:131], v[132:135], v[168:183]
    ds_read_b64_tr_b16 v[120:121], v186 offset:21504
    ds_read_b64_tr_b16 v[122:123], v186 offset:23296
    ds_read_b64_tr_b16 v[124:125], v186 offset:21568
    ds_read_b64_tr_b16 v[126:127], v186 offset:23360
    ds_read_b64_tr_b16 v[128:129], v186 offset:21632
    ds_read_b64_tr_b16 v[130:131], v186 offset:23424
    ds_read_b128 v[132:135], v189 offset:96
    s_waitcnt lgkmcnt(7)
    v_mfma_f32_32x32x16_bf16 v[136:151], v[104:107], v[116:119], v[136:151]
    v_mfma_f32_32x32x16_bf16 v[152:167], v[108:111], v[116:119], v[152:167]
    v_mfma_f32_32x32x16_bf16 v[168:183], v[112:115], v[116:119], v[168:183]
    ds_read_b64_tr_b16 v[104:105], v184 offset:0
    ds_read_b64_tr_b16 v[106:107], v184 offset:1792
    ds_read_b64_tr_b16 v[108:109], v184 offset:64
    ds_read_b64_tr_b16 v[110:111], v184 offset:1856
    ds_read_b64_tr_b16 v[112:113], v184 offset:128
    ds_read_b64_tr_b16 v[114:115], v184 offset:1920
    ds_read_b128 v[116:119], v187 offset:0
    s_waitcnt lgkmcnt(7)
    v_mfma_f32_32x32x16_bf16 v[136:151], v[120:123], v[132:135], v[136:151]
    v_mfma_f32_32x32x16_bf16 v[152:167], v[124:127], v[132:135], v[152:167]
    v_mfma_f32_32x32x16_bf16 v[168:183], v[128:131], v[132:135], v[168:183]
    s_barrier
    s_waitcnt vmcnt(10)
    v_add_u32 v19, 94208, v190
    ds_write_b128 v19, v[84:87]
    v_add_u32 v19, 94208, v191
    ds_write_b128 v19, v[88:91]
    v_add_u32 v19, 94208, v192
    ds_write_b128 v19, v[92:95]
    v_add_u32 v19, 94208, v13
    ds_write_b128 v19, v[96:99]
    v_add_u32 v19, 103424, v13
    ds_write_b128 v19, v[100:103]
    ds_read_b64_tr_b16 v[120:121], v184 offset:7168
    ds_read_b64_tr_b16 v[122:123], v184 offset:8960
    ds_read_b64_tr_b16 v[124:125], v184 offset:7232
    ds_read_b64_tr_b16 v[126:127], v184 offset:9024
    ds_read_b64_tr_b16 v[128:129], v184 offset:7296
    ds_read_b64_tr_b16 v[130:131], v184 offset:9088
    ds_read_b128 v[132:135], v187 offset:32
    s_waitcnt lgkmcnt(7)
    v_mfma_f32_32x32x16_bf16 v[136:151], v[104:107], v[116:119], v[136:151]
    v_mfma_f32_32x32x16_bf16 v[152:167], v[108:111], v[116:119], v[152:167]
    v_mfma_f32_32x32x16_bf16 v[168:183], v[112:115], v[116:119], v[168:183]
    ds_read_b64_tr_b16 v[104:105], v184 offset:14336
    ds_read_b64_tr_b16 v[106:107], v184 offset:16128
    ds_read_b64_tr_b16 v[108:109], v184 offset:14400
    ds_read_b64_tr_b16 v[110:111], v184 offset:16192
    ds_read_b64_tr_b16 v[112:113], v184 offset:14464
    ds_read_b64_tr_b16 v[114:115], v184 offset:16256
    ds_read_b128 v[116:119], v187 offset:64
    s_waitcnt lgkmcnt(7)
    v_mfma_f32_32x32x16_bf16 v[136:151], v[120:123], v[132:135], v[136:151]
    v_mfma_f32_32x32x16_bf16 v[152:167], v[124:127], v[132:135], v[152:167]
    v_mfma_f32_32x32x16_bf16 v[168:183], v[128:131], v[132:135], v[168:183]
    ds_read_b64_tr_b16 v[120:121], v184 offset:21504
    ds_read_b64_tr_b16 v[122:123], v184 offset:23296
    ds_read_b64_tr_b16 v[124:125], v184 offset:21568
    ds_read_b64_tr_b16 v[126:127], v184 offset:23360
    ds_read_b64_tr_b16 v[128:129], v184 offset:21632
    ds_read_b64_tr_b16 v[130:131], v184 offset:23424
    ds_read_b128 v[132:135], v187 offset:96
    s_waitcnt lgkmcnt(7)
    v_mfma_f32_32x32x16_bf16 v[136:151], v[104:107], v[116:119], v[136:151]
    v_mfma_f32_32x32x16_bf16 v[152:167], v[108:111], v[116:119], v[152:167]
    v_mfma_f32_32x32x16_bf16 v[168:183], v[112:115], v[116:119], v[168:183]
    ds_read_b64_tr_b16 v[104:105], v185 offset:0
    ds_read_b64_tr_b16 v[106:107], v185 offset:1792
    ds_read_b64_tr_b16 v[108:109], v185 offset:64
    ds_read_b64_tr_b16 v[110:111], v185 offset:1856
    ds_read_b64_tr_b16 v[112:113], v185 offset:128
    ds_read_b64_tr_b16 v[114:115], v185 offset:1920
    ds_read_b128 v[116:119], v188 offset:0
    s_waitcnt lgkmcnt(7)
    v_mfma_f32_32x32x16_bf16 v[136:151], v[120:123], v[132:135], v[136:151]
    v_mfma_f32_32x32x16_bf16 v[152:167], v[124:127], v[132:135], v[152:167]
    v_mfma_f32_32x32x16_bf16 v[168:183], v[128:131], v[132:135], v[168:183]
    s_barrier
    s_waitcnt vmcnt(5)
    ds_write_b128 v190, v[44:47] offset:0
    ds_write_b128 v191, v[48:51] offset:0
    ds_write_b128 v192, v[52:55] offset:0
    ds_write_b128 v13, v[56:59] offset:0
    ds_write_b128 v13, v[60:63] offset:9216
    ds_read_b64_tr_b16 v[120:121], v185 offset:7168
    ds_read_b64_tr_b16 v[122:123], v185 offset:8960
    ds_read_b64_tr_b16 v[124:125], v185 offset:7232
    ds_read_b64_tr_b16 v[126:127], v185 offset:9024
    ds_read_b64_tr_b16 v[128:129], v185 offset:7296
    ds_read_b64_tr_b16 v[130:131], v185 offset:9088
    ds_read_b128 v[132:135], v188 offset:32
    s_waitcnt lgkmcnt(7)
    v_mfma_f32_32x32x16_bf16 v[136:151], v[104:107], v[116:119], v[136:151]
    v_mfma_f32_32x32x16_bf16 v[152:167], v[108:111], v[116:119], v[152:167]
    v_mfma_f32_32x32x16_bf16 v[168:183], v[112:115], v[116:119], v[168:183]
    ds_read_b64_tr_b16 v[104:105], v185 offset:14336
    ds_read_b64_tr_b16 v[106:107], v185 offset:16128
    ds_read_b64_tr_b16 v[108:109], v185 offset:14400
    ds_read_b64_tr_b16 v[110:111], v185 offset:16192
    ds_read_b64_tr_b16 v[112:113], v185 offset:14464
    ds_read_b64_tr_b16 v[114:115], v185 offset:16256
    ds_read_b128 v[116:119], v188 offset:64
    s_waitcnt lgkmcnt(7)
    v_mfma_f32_32x32x16_bf16 v[136:151], v[120:123], v[132:135], v[136:151]
    v_mfma_f32_32x32x16_bf16 v[152:167], v[124:127], v[132:135], v[152:167]
    v_mfma_f32_32x32x16_bf16 v[168:183], v[128:131], v[132:135], v[168:183]
    ds_read_b64_tr_b16 v[120:121], v185 offset:21504
    ds_read_b64_tr_b16 v[122:123], v185 offset:23296
    ds_read_b64_tr_b16 v[124:125], v185 offset:21568
    ds_read_b64_tr_b16 v[126:127], v185 offset:23360
    ds_read_b64_tr_b16 v[128:129], v185 offset:21632
    ds_read_b64_tr_b16 v[130:131], v185 offset:23424
    ds_read_b128 v[132:135], v188 offset:96
    s_waitcnt lgkmcnt(7)
    v_mfma_f32_32x32x16_bf16 v[136:151], v[104:107], v[116:119], v[136:151]
    v_mfma_f32_32x32x16_bf16 v[152:167], v[108:111], v[116:119], v[152:167]
    v_mfma_f32_32x32x16_bf16 v[168:183], v[112:115], v[116:119], v[168:183]
    ds_read_b64_tr_b16 v[104:105], v186 offset:0
    ds_read_b64_tr_b16 v[106:107], v186 offset:1792
    ds_read_b64_tr_b16 v[108:109], v186 offset:64
    ds_read_b64_tr_b16 v[110:111], v186 offset:1856
    ds_read_b64_tr_b16 v[112:113], v186 offset:128
    ds_read_b64_tr_b16 v[114:115], v186 offset:1920
    ds_read_b128 v[116:119], v189 offset:0
    s_waitcnt lgkmcnt(7)
    v_mfma_f32_32x32x16_bf16 v[136:151], v[120:123], v[132:135], v[136:151]
    v_mfma_f32_32x32x16_bf16 v[152:167], v[124:127], v[132:135], v[152:167]
    v_mfma_f32_32x32x16_bf16 v[168:183], v[128:131], v[132:135], v[168:183]
    s_barrier
    s_waitcnt vmcnt(0)
    ds_write_b128 v190, v[64:67] offset:47104
    ds_write_b128 v191, v[68:71] offset:47104
    ds_write_b128 v192, v[72:75] offset:47104
    ds_write_b128 v13, v[76:79] offset:47104
    ds_write_b128 v13, v[80:83] offset:56320
    ds_read_b64_tr_b16 v[120:121], v186 offset:7168
    ds_read_b64_tr_b16 v[122:123], v186 offset:8960
    ds_read_b64_tr_b16 v[124:125], v186 offset:7232
    ds_read_b64_tr_b16 v[126:127], v186 offset:9024
    ds_read_b64_tr_b16 v[128:129], v186 offset:7296
    ds_read_b64_tr_b16 v[130:131], v186 offset:9088
    ds_read_b128 v[132:135], v189 offset:32
    s_waitcnt lgkmcnt(7)
    v_mfma_f32_32x32x16_bf16 v[136:151], v[104:107], v[116:119], v[136:151]
    v_mfma_f32_32x32x16_bf16 v[152:167], v[108:111], v[116:119], v[152:167]
    v_mfma_f32_32x32x16_bf16 v[168:183], v[112:115], v[116:119], v[168:183]
    ds_read_b64_tr_b16 v[104:105], v186 offset:14336
    ds_read_b64_tr_b16 v[106:107], v186 offset:16128
    ds_read_b64_tr_b16 v[108:109], v186 offset:14400
    ds_read_b64_tr_b16 v[110:111], v186 offset:16192
    ds_read_b64_tr_b16 v[112:113], v186 offset:14464
    ds_read_b64_tr_b16 v[114:115], v186 offset:16256
    ds_read_b128 v[116:119], v189 offset:64
    s_waitcnt lgkmcnt(7)
    v_mfma_f32_32x32x16_bf16 v[136:151], v[120:123], v[132:135], v[136:151]
    v_mfma_f32_32x32x16_bf16 v[152:167], v[124:127], v[132:135], v[152:167]
    v_mfma_f32_32x32x16_bf16 v[168:183], v[128:131], v[132:135], v[168:183]
    ds_read_b64_tr_b16 v[120:121], v186 offset:21504
    ds_read_b64_tr_b16 v[122:123], v186 offset:23296
    ds_read_b64_tr_b16 v[124:125], v186 offset:21568
    ds_read_b64_tr_b16 v[126:127], v186 offset:23360
    ds_read_b64_tr_b16 v[128:129], v186 offset:21632
    ds_read_b64_tr_b16 v[130:131], v186 offset:23424
    ds_read_b128 v[132:135], v189 offset:96
    s_waitcnt lgkmcnt(7)
    v_mfma_f32_32x32x16_bf16 v[136:151], v[104:107], v[116:119], v[136:151]
    v_mfma_f32_32x32x16_bf16 v[152:167], v[108:111], v[116:119], v[152:167]
    v_mfma_f32_32x32x16_bf16 v[168:183], v[112:115], v[116:119], v[168:183]
    ds_read_b64_tr_b16 v[104:105], v184 offset:0
    ds_read_b64_tr_b16 v[106:107], v184 offset:1792
    ds_read_b64_tr_b16 v[108:109], v184 offset:64
    ds_read_b64_tr_b16 v[110:111], v184 offset:1856
    ds_read_b64_tr_b16 v[112:113], v184 offset:128
    ds_read_b64_tr_b16 v[114:115], v184 offset:1920
    ds_read_b128 v[116:119], v187 offset:0
    s_waitcnt lgkmcnt(7)
    v_mfma_f32_32x32x16_bf16 v[136:151], v[120:123], v[132:135], v[136:151]
    v_mfma_f32_32x32x16_bf16 v[152:167], v[124:127], v[132:135], v[152:167]
    v_mfma_f32_32x32x16_bf16 v[168:183], v[128:131], v[132:135], v[168:183]
    s_barrier
    ds_read_b64_tr_b16 v[120:121], v184 offset:7168
    ds_read_b64_tr_b16 v[122:123], v184 offset:8960
    ds_read_b64_tr_b16 v[124:125], v184 offset:7232
    ds_read_b64_tr_b16 v[126:127], v184 offset:9024
    ds_read_b64_tr_b16 v[128:129], v184 offset:7296
    ds_read_b64_tr_b16 v[130:131], v184 offset:9088
    ds_read_b128 v[132:135], v187 offset:32
    s_waitcnt lgkmcnt(7)
    v_mfma_f32_32x32x16_bf16 v[136:151], v[104:107], v[116:119], v[136:151]
    v_mfma_f32_32x32x16_bf16 v[152:167], v[108:111], v[116:119], v[152:167]
    v_mfma_f32_32x32x16_bf16 v[168:183], v[112:115], v[116:119], v[168:183]
    ds_read_b64_tr_b16 v[104:105], v184 offset:14336
    ds_read_b64_tr_b16 v[106:107], v184 offset:16128
    ds_read_b64_tr_b16 v[108:109], v184 offset:14400
    ds_read_b64_tr_b16 v[110:111], v184 offset:16192
    ds_read_b64_tr_b16 v[112:113], v184 offset:14464
    ds_read_b64_tr_b16 v[114:115], v184 offset:16256
    ds_read_b128 v[116:119], v187 offset:64
    s_waitcnt lgkmcnt(7)
    v_mfma_f32_32x32x16_bf16 v[136:151], v[120:123], v[132:135], v[136:151]
    v_mfma_f32_32x32x16_bf16 v[152:167], v[124:127], v[132:135], v[152:167]
    v_mfma_f32_32x32x16_bf16 v[168:183], v[128:131], v[132:135], v[168:183]
    ds_read_b64_tr_b16 v[120:121], v184 offset:21504
    ds_read_b64_tr_b16 v[122:123], v184 offset:23296
    ds_read_b64_tr_b16 v[124:125], v184 offset:21568
    ds_read_b64_tr_b16 v[126:127], v184 offset:23360
    ds_read_b64_tr_b16 v[128:129], v184 offset:21632
    ds_read_b64_tr_b16 v[130:131], v184 offset:23424
    ds_read_b128 v[132:135], v187 offset:96
    s_waitcnt lgkmcnt(7)
    v_mfma_f32_32x32x16_bf16 v[136:151], v[104:107], v[116:119], v[136:151]
    v_mfma_f32_32x32x16_bf16 v[152:167], v[108:111], v[116:119], v[152:167]
    v_mfma_f32_32x32x16_bf16 v[168:183], v[112:115], v[116:119], v[168:183]
    ds_read_b64_tr_b16 v[104:105], v185 offset:0
    ds_read_b64_tr_b16 v[106:107], v185 offset:1792
    ds_read_b64_tr_b16 v[108:109], v185 offset:64
    ds_read_b64_tr_b16 v[110:111], v185 offset:1856
    ds_read_b64_tr_b16 v[112:113], v185 offset:128
    ds_read_b64_tr_b16 v[114:115], v185 offset:1920
    ds_read_b128 v[116:119], v188 offset:0
    s_waitcnt lgkmcnt(7)
    v_mfma_f32_32x32x16_bf16 v[136:151], v[120:123], v[132:135], v[136:151]
    v_mfma_f32_32x32x16_bf16 v[152:167], v[124:127], v[132:135], v[152:167]
    v_mfma_f32_32x32x16_bf16 v[168:183], v[128:131], v[132:135], v[168:183]
    s_barrier
    ds_read_b64_tr_b16 v[120:121], v185 offset:7168
    ds_read_b64_tr_b16 v[122:123], v185 offset:8960
    ds_read_b64_tr_b16 v[124:125], v185 offset:7232
    ds_read_b64_tr_b16 v[126:127], v185 offset:9024
    ds_read_b64_tr_b16 v[128:129], v185 offset:7296
    ds_read_b64_tr_b16 v[130:131], v185 offset:9088
    ds_read_b128 v[132:135], v188 offset:32
    s_waitcnt lgkmcnt(7)
    v_mfma_f32_32x32x16_bf16 v[136:151], v[104:107], v[116:119], v[136:151]
    v_mfma_f32_32x32x16_bf16 v[152:167], v[108:111], v[116:119], v[152:167]
    v_mfma_f32_32x32x16_bf16 v[168:183], v[112:115], v[116:119], v[168:183]
    ds_read_b64_tr_b16 v[104:105], v185 offset:14336
    ds_read_b64_tr_b16 v[106:107], v185 offset:16128
    ds_read_b64_tr_b16 v[108:109], v185 offset:14400
    ds_read_b64_tr_b16 v[110:111], v185 offset:16192
    ds_read_b64_tr_b16 v[112:113], v185 offset:14464
    ds_read_b64_tr_b16 v[114:115], v185 offset:16256
    ds_read_b128 v[116:119], v188 offset:64
    s_waitcnt lgkmcnt(7)
    v_mfma_f32_32x32x16_bf16 v[136:151], v[120:123], v[132:135], v[136:151]
    v_mfma_f32_32x32x16_bf16 v[152:167], v[124:127], v[132:135], v[152:167]
    v_mfma_f32_32x32x16_bf16 v[168:183], v[128:131], v[132:135], v[168:183]
    ds_read_b64_tr_b16 v[120:121], v185 offset:21504
    ds_read_b64_tr_b16 v[122:123], v185 offset:23296
    ds_read_b64_tr_b16 v[124:125], v185 offset:21568
    ds_read_b64_tr_b16 v[126:127], v185 offset:23360
    ds_read_b64_tr_b16 v[128:129], v185 offset:21632
    ds_read_b64_tr_b16 v[130:131], v185 offset:23424
    ds_read_b128 v[132:135], v188 offset:96
    s_waitcnt lgkmcnt(7)
    v_mfma_f32_32x32x16_bf16 v[136:151], v[104:107], v[116:119], v[136:151]
    v_mfma_f32_32x32x16_bf16 v[152:167], v[108:111], v[116:119], v[152:167]
    v_mfma_f32_32x32x16_bf16 v[168:183], v[112:115], v[116:119], v[168:183]
    s_waitcnt lgkmcnt(0)
    v_mfma_f32_32x32x16_bf16 v[136:151], v[120:123], v[132:135], v[136:151]
    v_mfma_f32_32x32x16_bf16 v[152:167], v[124:127], v[132:135], v[152:167]
    v_mfma_f32_32x32x16_bf16 v[168:183], v[128:131], v[132:135], v[168:183]
    s_nop 7
    s_nop 7
    s_mov_b32 s46, 0xbfb8aa3b
    s_mov_b32 s48, 0x4038aa3b
    s_mov_b32 s49, 0x4038aa3b
    s_mov_b32 s50, 0x3f317218
    s_mov_b32 s51, 0x3f317218
    s_mul_i32 s52, s25, 96
    s_add_u32 s52, s52, s23
    s_add_u32 s52, s52, 0
    s_cmp_ge_u32 s52, 1408
    s_cbranch_scc1 L_g1_skip0
    v_lshlrev_b32 v44, 16, v20
    v_and_b32 v45, 0xffff0000, v20
    v_cvt_pk_bf16_f32 v51, v136, v137
    v_lshlrev_b32 v136, 16, v51
    v_and_b32 v137, 0xffff0000, v51
    v_pk_add_f32 v[136:137], v[136:137], v[44:45]
    v_cvt_pk_bf16_f32 v51, v136, v137
    v_lshlrev_b32 v136, 16, v51
    v_and_b32 v137, 0xffff0000, v51
    v_mul_f32_e64 v46, s46, |v136|
    v_mul_f32_e64 v47, s46, |v137|
    v_exp_f32 v46, v46
    v_exp_f32 v47, v47
    s_nop 0
    v_cvt_pk_bf16_f32 v51, v46, v47
    v_lshlrev_b32 v46, 16, v51
    v_and_b32 v47, 0xffff0000, v51
    v_pk_add_f32 v[48:49], v[46:47], 1.0
    v_pk_add_f32 v[52:53], v[48:49], -1.0
    v_pk_add_f32 v[46:47], v[46:47], v[52:53] neg_lo:[0,1] neg_hi:[0,1]
    v_log_f32 v48, v48
    v_log_f32 v49, v49
    s_nop 0
    v_pk_fma_f32 v[46:47], v[48:49], s[50:51], v[46:47] op_sel_hi:[1,0,1]
    v_cvt_pk_bf16_f32 v51, v46, v47
    v_lshlrev_b32 v46, 16, v51
    v_and_b32 v47, 0xffff0000, v51
    v_max_f32 v48, 0, v136
    v_max_f32 v49, 0, v137
    v_pk_add_f32 v[46:47], v[46:47], v[48:49]
    v_cvt_pk_bf16_f32 v51, v46, v47
    v_lshlrev_b32 v46, 16, v51
    v_and_b32 v47, 0xffff0000, v51
    v_pk_mul_f32 v[46:47], v[46:47], s[48:49] op_sel_hi:[1,0]
    v_exp_f32 v46, v46
    v_exp_f32 v47, v47
    s_nop 0
    v_pk_add_f32 v[46:47], v[46:47], 1.0
    v_rcp_f32 v46, v46
    v_rcp_f32 v47, v47
    s_nop 0
    v_pk_fma_f32 v[46:47], v[46:47], -2.0, 1.0
    v_cvt_pk_bf16_f32 v51, v46, v47
    v_lshlrev_b32 v46, 16, v51
    v_and_b32 v47, 0xffff0000, v51
    v_pk_mul_f32 v[136:137], v[136:137], v[46:47]
    v_cvt_pk_bf16_f32 v54, v136, v137
    v_lshlrev_b32 v44, 16, v21
    v_and_b32 v45, 0xffff0000, v21
    v_cvt_pk_bf16_f32 v51, v138, v139
    v_lshlrev_b32 v138, 16, v51
    v_and_b32 v139, 0xffff0000, v51
    v_pk_add_f32 v[138:139], v[138:139], v[44:45]
    v_cvt_pk_bf16_f32 v51, v138, v139
    v_lshlrev_b32 v138, 16, v51
    v_and_b32 v139, 0xffff0000, v51
    v_mul_f32_e64 v46, s46, |v138|
    v_mul_f32_e64 v47, s46, |v139|
    v_exp_f32 v46, v46
    v_exp_f32 v47, v47
    s_nop 0
    v_cvt_pk_bf16_f32 v51, v46, v47
    v_lshlrev_b32 v46, 16, v51
    v_and_b32 v47, 0xffff0000, v51
    v_pk_add_f32 v[48:49], v[46:47], 1.0
    v_pk_add_f32 v[52:53], v[48:49], -1.0
    v_pk_add_f32 v[46:47], v[46:47], v[52:53] neg_lo:[0,1] neg_hi:[0,1]
    v_log_f32 v48, v48
    v_log_f32 v49, v49
    s_nop 0
    v_pk_fma_f32 v[46:47], v[48:49], s[50:51], v[46:47] op_sel_hi:[1,0,1]
    v_cvt_pk_bf16_f32 v51, v46, v47
    v_lshlrev_b32 v46, 16, v51
    v_and_b32 v47, 0xffff0000, v51
    v_max_f32 v48, 0, v138
    v_max_f32 v49, 0, v139
    v_pk_add_f32 v[46:47], v[46:47], v[48:49]
    v_cvt_pk_bf16_f32 v51, v46, v47
    v_lshlrev_b32 v46, 16, v51
    v_and_b32 v47, 0xffff0000, v51
    v_pk_mul_f32 v[46:47], v[46:47], s[48:49] op_sel_hi:[1,0]
    v_exp_f32 v46, v46
    v_exp_f32 v47, v47
    s_nop 0
    v_pk_add_f32 v[46:47], v[46:47], 1.0
    v_rcp_f32 v46, v46
    v_rcp_f32 v47, v47
    s_nop 0
    v_pk_fma_f32 v[46:47], v[46:47], -2.0, 1.0
    v_cvt_pk_bf16_f32 v51, v46, v47
    v_lshlrev_b32 v46, 16, v51
    v_and_b32 v47, 0xffff0000, v51
    v_pk_mul_f32 v[138:139], v[138:139], v[46:47]
    v_cvt_pk_bf16_f32 v55, v138, v139
    buffer_store_dwordx2 v[54:55], v16, s[40:43], 0 offen offset:0
    s_nop 0
    v_lshlrev_b32 v44, 16, v22
    v_and_b32 v45, 0xffff0000, v22
    v_cvt_pk_bf16_f32 v51, v140, v141
    v_lshlrev_b32 v140, 16, v51
    v_and_b32 v141, 0xffff0000, v51
    v_pk_add_f32 v[140:141], v[140:141], v[44:45]
    v_cvt_pk_bf16_f32 v51, v140, v141
    v_lshlrev_b32 v140, 16, v51
    v_and_b32 v141, 0xffff0000, v51
    v_mul_f32_e64 v46, s46, |v140|
    v_mul_f32_e64 v47, s46, |v141|
    v_exp_f32 v46, v46
    v_exp_f32 v47, v47
    s_nop 0
    v_cvt_pk_bf16_f32 v51, v46, v47
    v_lshlrev_b32 v46, 16, v51
    v_and_b32 v47, 0xffff0000, v51
    v_pk_add_f32 v[48:49], v[46:47], 1.0
    v_pk_add_f32 v[52:53], v[48:49], -1.0
    v_pk_add_f32 v[46:47], v[46:47], v[52:53] neg_lo:[0,1] neg_hi:[0,1]
    v_log_f32 v48, v48
    v_log_f32 v49, v49
    s_nop 0
    v_pk_fma_f32 v[46:47], v[48:49], s[50:51], v[46:47] op_sel_hi:[1,0,1]
    v_cvt_pk_bf16_f32 v51, v46, v47
    v_lshlrev_b32 v46, 16, v51
    v_and_b32 v47, 0xffff0000, v51
    v_max_f32 v48, 0, v140
    v_max_f32 v49, 0, v141
    v_pk_add_f32 v[46:47], v[46:47], v[48:49]
    v_cvt_pk_bf16_f32 v51, v46, v47
    v_lshlrev_b32 v46, 16, v51
    v_and_b32 v47, 0xffff0000, v51
    v_pk_mul_f32 v[46:47], v[46:47], s[48:49] op_sel_hi:[1,0]
    v_exp_f32 v46, v46
    v_exp_f32 v47, v47
    s_nop 0
    v_pk_add_f32 v[46:47], v[46:47], 1.0
    v_rcp_f32 v46, v46
    v_rcp_f32 v47, v47
    s_nop 0
    v_pk_fma_f32 v[46:47], v[46:47], -2.0, 1.0
    v_cvt_pk_bf16_f32 v51, v46, v47
    v_lshlrev_b32 v46, 16, v51
    v_and_b32 v47, 0xffff0000, v51
    v_pk_mul_f32 v[140:141], v[140:141], v[46:47]
    v_cvt_pk_bf16_f32 v54, v140, v141
    v_lshlrev_b32 v44, 16, v23
    v_and_b32 v45, 0xffff0000, v23
    v_cvt_pk_bf16_f32 v51, v142, v143
    v_lshlrev_b32 v142, 16, v51
    v_and_b32 v143, 0xffff0000, v51
    v_pk_add_f32 v[142:143], v[142:143], v[44:45]
    v_cvt_pk_bf16_f32 v51, v142, v143
    v_lshlrev_b32 v142, 16, v51
    v_and_b32 v143, 0xffff0000, v51
    v_mul_f32_e64 v46, s46, |v142|
    v_mul_f32_e64 v47, s46, |v143|
    v_exp_f32 v46, v46
    v_exp_f32 v47, v47
    s_nop 0
    v_cvt_pk_bf16_f32 v51, v46, v47
    v_lshlrev_b32 v46, 16, v51
    v_and_b32 v47, 0xffff0000, v51
    v_pk_add_f32 v[48:49], v[46:47], 1.0
    v_pk_add_f32 v[52:53], v[48:49], -1.0
    v_pk_add_f32 v[46:47], v[46:47], v[52:53] neg_lo:[0,1] neg_hi:[0,1]
    v_log_f32 v48, v48
    v_log_f32 v49, v49
    s_nop 0
    v_pk_fma_f32 v[46:47], v[48:49], s[50:51], v[46:47] op_sel_hi:[1,0,1]
    v_cvt_pk_bf16_f32 v51, v46, v47
    v_lshlrev_b32 v46, 16, v51
    v_and_b32 v47, 0xffff0000, v51
    v_max_f32 v48, 0, v142
    v_max_f32 v49, 0, v143
    v_pk_add_f32 v[46:47], v[46:47], v[48:49]
    v_cvt_pk_bf16_f32 v51, v46, v47
    v_lshlrev_b32 v46, 16, v51
    v_and_b32 v47, 0xffff0000, v51
    v_pk_mul_f32 v[46:47], v[46:47], s[48:49] op_sel_hi:[1,0]
    v_exp_f32 v46, v46
    v_exp_f32 v47, v47
    s_nop 0
    v_pk_add_f32 v[46:47], v[46:47], 1.0
    v_rcp_f32 v46, v46
    v_rcp_f32 v47, v47
    s_nop 0
    v_pk_fma_f32 v[46:47], v[46:47], -2.0, 1.0
    v_cvt_pk_bf16_f32 v51, v46, v47
    v_lshlrev_b32 v46, 16, v51
    v_and_b32 v47, 0xffff0000, v51
    v_pk_mul_f32 v[142:143], v[142:143], v[46:47]
    v_cvt_pk_bf16_f32 v55, v142, v143
    buffer_store_dwordx2 v[54:55], v16, s[40:43], 0 offen offset:16
    s_nop 0
    v_lshlrev_b32 v44, 16, v24
    v_and_b32 v45, 0xffff0000, v24
    v_cvt_pk_bf16_f32 v51, v144, v145
    v_lshlrev_b32 v144, 16, v51
    v_and_b32 v145, 0xffff0000, v51
    v_pk_add_f32 v[144:145], v[144:145], v[44:45]
    v_cvt_pk_bf16_f32 v51, v144, v145
    v_lshlrev_b32 v144, 16, v51
    v_and_b32 v145, 0xffff0000, v51
    v_mul_f32_e64 v46, s46, |v144|
    v_mul_f32_e64 v47, s46, |v145|
    v_exp_f32 v46, v46
    v_exp_f32 v47, v47
    s_nop 0
    v_cvt_pk_bf16_f32 v51, v46, v47
    v_lshlrev_b32 v46, 16, v51
    v_and_b32 v47, 0xffff0000, v51
    v_pk_add_f32 v[48:49], v[46:47], 1.0
    v_pk_add_f32 v[52:53], v[48:49], -1.0
    v_pk_add_f32 v[46:47], v[46:47], v[52:53] neg_lo:[0,1] neg_hi:[0,1]
    v_log_f32 v48, v48
    v_log_f32 v49, v49
    s_nop 0
    v_pk_fma_f32 v[46:47], v[48:49], s[50:51], v[46:47] op_sel_hi:[1,0,1]
    v_cvt_pk_bf16_f32 v51, v46, v47
    v_lshlrev_b32 v46, 16, v51
    v_and_b32 v47, 0xffff0000, v51
    v_max_f32 v48, 0, v144
    v_max_f32 v49, 0, v145
    v_pk_add_f32 v[46:47], v[46:47], v[48:49]
    v_cvt_pk_bf16_f32 v51, v46, v47
    v_lshlrev_b32 v46, 16, v51
    v_and_b32 v47, 0xffff0000, v51
    v_pk_mul_f32 v[46:47], v[46:47], s[48:49] op_sel_hi:[1,0]
    v_exp_f32 v46, v46
    v_exp_f32 v47, v47
    s_nop 0
    v_pk_add_f32 v[46:47], v[46:47], 1.0
    v_rcp_f32 v46, v46
    v_rcp_f32 v47, v47
    s_nop 0
    v_pk_fma_f32 v[46:47], v[46:47], -2.0, 1.0
    v_cvt_pk_bf16_f32 v51, v46, v47
    v_lshlrev_b32 v46, 16, v51
    v_and_b32 v47, 0xffff0000, v51
    v_pk_mul_f32 v[144:145], v[144:145], v[46:47]
    v_cvt_pk_bf16_f32 v54, v144, v145
    v_lshlrev_b32 v44, 16, v25
    v_and_b32 v45, 0xffff0000, v25
    v_cvt_pk_bf16_f32 v51, v146, v147
    v_lshlrev_b32 v146, 16, v51
    v_and_b32 v147, 0xffff0000, v51
    v_pk_add_f32 v[146:147], v[146:147], v[44:45]
    v_cvt_pk_bf16_f32 v51, v146, v147
    v_lshlrev_b32 v146, 16, v51
    v_and_b32 v147, 0xffff0000, v51
    v_mul_f32_e64 v46, s46, |v146|
    v_mul_f32_e64 v47, s46, |v147|
    v_exp_f32 v46, v46
    v_exp_f32 v47, v47
    s_nop 0
    v_cvt_pk_bf16_f32 v51, v46, v47
    v_lshlrev_b32 v46, 16, v51
    v_and_b32 v47, 0xffff0000, v51
    v_pk_add_f32 v[48:49], v[46:47], 1.0
    v_pk_add_f32 v[52:53], v[48:49], -1.0
    v_pk_add_f32 v[46:47], v[46:47], v[52:53] neg_lo:[0,1] neg_hi:[0,1]
    v_log_f32 v48, v48
    v_log_f32 v49, v49
    s_nop 0
    v_pk_fma_f32 v[46:47], v[48:49], s[50:51], v[46:47] op_sel_hi:[1,0,1]
    v_cvt_pk_bf16_f32 v51, v46, v47
    v_lshlrev_b32 v46, 16, v51
    v_and_b32 v47, 0xffff0000, v51
    v_max_f32 v48, 0, v146
    v_max_f32 v49, 0, v147
    v_pk_add_f32 v[46:47], v[46:47], v[48:49]
    v_cvt_pk_bf16_f32 v51, v46, v47
    v_lshlrev_b32 v46, 16, v51
    v_and_b32 v47, 0xffff0000, v51
    v_pk_mul_f32 v[46:47], v[46:47], s[48:49] op_sel_hi:[1,0]
    v_exp_f32 v46, v46
    v_exp_f32 v47, v47
    s_nop 0
    v_pk_add_f32 v[46:47], v[46:47], 1.0
    v_rcp_f32 v46, v46
    v_rcp_f32 v47, v47
    s_nop 0
    v_pk_fma_f32 v[46:47], v[46:47], -2.0, 1.0
    v_cvt_pk_bf16_f32 v51, v46, v47
    v_lshlrev_b32 v46, 16, v51
    v_and_b32 v47, 0xffff0000, v51
    v_pk_mul_f32 v[146:147], v[146:147], v[46:47]
    v_cvt_pk_bf16_f32 v55, v146, v147
    buffer_store_dwordx2 v[54:55], v16, s[40:43], 0 offen offset:32
    s_nop 0
    v_lshlrev_b32 v44, 16, v26
    v_and_b32 v45, 0xffff0000, v26
    v_cvt_pk_bf16_f32 v51, v148, v149
    v_lshlrev_b32 v148, 16, v51
    v_and_b32 v149, 0xffff0000, v51
    v_pk_add_f32 v[148:149], v[148:149], v[44:45]
    v_cvt_pk_bf16_f32 v51, v148, v149
    v_lshlrev_b32 v148, 16, v51
    v_and_b32 v149, 0xffff0000, v51
    v_mul_f32_e64 v46, s46, |v148|
    v_mul_f32_e64 v47, s46, |v149|
    v_exp_f32 v46, v46
    v_exp_f32 v47, v47
    s_nop 0
    v_cvt_pk_bf16_f32 v51, v46, v47
    v_lshlrev_b32 v46, 16, v51
    v_and_b32 v47, 0xffff0000, v51
    v_pk_add_f32 v[48:49], v[46:47], 1.0
    v_pk_add_f32 v[52:53], v[48:49], -1.0
    v_pk_add_f32 v[46:47], v[46:47], v[52:53] neg_lo:[0,1] neg_hi:[0,1]
    v_log_f32 v48, v48
    v_log_f32 v49, v49
    s_nop 0
    v_pk_fma_f32 v[46:47], v[48:49], s[50:51], v[46:47] op_sel_hi:[1,0,1]
    v_cvt_pk_bf16_f32 v51, v46, v47
    v_lshlrev_b32 v46, 16, v51
    v_and_b32 v47, 0xffff0000, v51
    v_max_f32 v48, 0, v148
    v_max_f32 v49, 0, v149
    v_pk_add_f32 v[46:47], v[46:47], v[48:49]
    v_cvt_pk_bf16_f32 v51, v46, v47
    v_lshlrev_b32 v46, 16, v51
    v_and_b32 v47, 0xffff0000, v51
    v_pk_mul_f32 v[46:47], v[46:47], s[48:49] op_sel_hi:[1,0]
    v_exp_f32 v46, v46
    v_exp_f32 v47, v47
    s_nop 0
    v_pk_add_f32 v[46:47], v[46:47], 1.0
    v_rcp_f32 v46, v46
    v_rcp_f32 v47, v47
    s_nop 0
    v_pk_fma_f32 v[46:47], v[46:47], -2.0, 1.0
    v_cvt_pk_bf16_f32 v51, v46, v47
    v_lshlrev_b32 v46, 16, v51
    v_and_b32 v47, 0xffff0000, v51
    v_pk_mul_f32 v[148:149], v[148:149], v[46:47]
    v_cvt_pk_bf16_f32 v54, v148, v149
    v_lshlrev_b32 v44, 16, v27
    v_and_b32 v45, 0xffff0000, v27
    v_cvt_pk_bf16_f32 v51, v150, v151
    v_lshlrev_b32 v150, 16, v51
    v_and_b32 v151, 0xffff0000, v51
    v_pk_add_f32 v[150:151], v[150:151], v[44:45]
    v_cvt_pk_bf16_f32 v51, v150, v151
    v_lshlrev_b32 v150, 16, v51
    v_and_b32 v151, 0xffff0000, v51
    v_mul_f32_e64 v46, s46, |v150|
    v_mul_f32_e64 v47, s46, |v151|
    v_exp_f32 v46, v46
    v_exp_f32 v47, v47
    s_nop 0
    v_cvt_pk_bf16_f32 v51, v46, v47
    v_lshlrev_b32 v46, 16, v51
    v_and_b32 v47, 0xffff0000, v51
    v_pk_add_f32 v[48:49], v[46:47], 1.0
    v_pk_add_f32 v[52:53], v[48:49], -1.0
    v_pk_add_f32 v[46:47], v[46:47], v[52:53] neg_lo:[0,1] neg_hi:[0,1]
    v_log_f32 v48, v48
    v_log_f32 v49, v49
    s_nop 0
    v_pk_fma_f32 v[46:47], v[48:49], s[50:51], v[46:47] op_sel_hi:[1,0,1]
    v_cvt_pk_bf16_f32 v51, v46, v47
    v_lshlrev_b32 v46, 16, v51
    v_and_b32 v47, 0xffff0000, v51
    v_max_f32 v48, 0, v150
    v_max_f32 v49, 0, v151
    v_pk_add_f32 v[46:47], v[46:47], v[48:49]
    v_cvt_pk_bf16_f32 v51, v46, v47
    v_lshlrev_b32 v46, 16, v51
    v_and_b32 v47, 0xffff0000, v51
    v_pk_mul_f32 v[46:47], v[46:47], s[48:49] op_sel_hi:[1,0]
    v_exp_f32 v46, v46
    v_exp_f32 v47, v47
    s_nop 0
    v_pk_add_f32 v[46:47], v[46:47], 1.0
    v_rcp_f32 v46, v46
    v_rcp_f32 v47, v47
    s_nop 0
    v_pk_fma_f32 v[46:47], v[46:47], -2.0, 1.0
    v_cvt_pk_bf16_f32 v51, v46, v47
    v_lshlrev_b32 v46, 16, v51
    v_and_b32 v47, 0xffff0000, v51
    v_pk_mul_f32 v[150:151], v[150:151], v[46:47]
    v_cvt_pk_bf16_f32 v55, v150, v151
    buffer_store_dwordx2 v[54:55], v16, s[40:43], 0 offen offset:48
    s_nop 0
L_g1_skip0:
    s_mul_i32 s52, s25, 96
    s_add_u32 s52, s52, s23
    s_add_u32 s52, s52, 32
    s_cmp_ge_u32 s52, 1408
    s_cbranch_scc1 L_g1_skip1
    v_lshlrev_b32 v44, 16, v28
    v_and_b32 v45, 0xffff0000, v28
    v_cvt_pk_bf16_f32 v51, v152, v153
    v_lshlrev_b32 v152, 16, v51
    v_and_b32 v153, 0xffff0000, v51
    v_pk_add_f32 v[152:153], v[152:153], v[44:45]
    v_cvt_pk_bf16_f32 v51, v152, v153
    v_lshlrev_b32 v152, 16, v51
    v_and_b32 v153, 0xffff0000, v51
    v_mul_f32_e64 v46, s46, |v152|
    v_mul_f32_e64 v47, s46, |v153|
    v_exp_f32 v46, v46
    v_exp_f32 v47, v47
    s_nop 0
    v_cvt_pk_bf16_f32 v51, v46, v47
    v_lshlrev_b32 v46, 16, v51
    v_and_b32 v47, 0xffff0000, v51
    v_pk_add_f32 v[48:49], v[46:47], 1.0
    v_pk_add_f32 v[52:53], v[48:49], -1.0
    v_pk_add_f32 v[46:47], v[46:47], v[52:53] neg_lo:[0,1] neg_hi:[0,1]
    v_log_f32 v48, v48
    v_log_f32 v49, v49
    s_nop 0
    v_pk_fma_f32 v[46:47], v[48:49], s[50:51], v[46:47] op_sel_hi:[1,0,1]
    v_cvt_pk_bf16_f32 v51, v46, v47
    v_lshlrev_b32 v46, 16, v51
    v_and_b32 v47, 0xffff0000, v51
    v_max_f32 v48, 0, v152
    v_max_f32 v49, 0, v153
    v_pk_add_f32 v[46:47], v[46:47], v[48:49]
    v_cvt_pk_bf16_f32 v51, v46, v47
    v_lshlrev_b32 v46, 16, v51
    v_and_b32 v47, 0xffff0000, v51
    v_pk_mul_f32 v[46:47], v[46:47], s[48:49] op_sel_hi:[1,0]
    v_exp_f32 v46, v46
    v_exp_f32 v47, v47
    s_nop 0
    v_pk_add_f32 v[46:47], v[46:47], 1.0
    v_rcp_f32 v46, v46
    v_rcp_f32 v47, v47
    s_nop 0
    v_pk_fma_f32 v[46:47], v[46:47], -2.0, 1.0
    v_cvt_pk_bf16_f32 v51, v46, v47
    v_lshlrev_b32 v46, 16, v51
    v_and_b32 v47, 0xffff0000, v51
    v_pk_mul_f32 v[152:153], v[152:153], v[46:47]
    v_cvt_pk_bf16_f32 v54, v152, v153
    v_lshlrev_b32 v44, 16, v29
    v_and_b32 v45, 0xffff0000, v29
    v_cvt_pk_bf16_f32 v51, v154, v155
    v_lshlrev_b32 v154, 16, v51
    v_and_b32 v155, 0xffff0000, v51
    v_pk_add_f32 v[154:155], v[154:155], v[44:45]
    v_cvt_pk_bf16_f32 v51, v154, v155
    v_lshlrev_b32 v154, 16, v51
    v_and_b32 v155, 0xffff0000, v51
    v_mul_f32_e64 v46, s46, |v154|
    v_mul_f32_e64 v47, s46, |v155|
    v_exp_f32 v46, v46
    v_exp_f32 v47, v47
    s_nop 0
    v_cvt_pk_bf16_f32 v51, v46, v47
    v_lshlrev_b32 v46, 16, v51
    v_and_b32 v47, 0xffff0000, v51
    v_pk_add_f32 v[48:49], v[46:47], 1.0
    v_pk_add_f32 v[52:53], v[48:49], -1.0
    v_pk_add_f32 v[46:47], v[46:47], v[52:53] neg_lo:[0,1] neg_hi:[0,1]
    v_log_f32 v48, v48
    v_log_f32 v49, v49
    s_nop 0
    v_pk_fma_f32 v[46:47], v[48:49], s[50:51], v[46:47] op_sel_hi:[1,0,1]
    v_cvt_pk_bf16_f32 v51, v46, v47
    v_lshlrev_b32 v46, 16, v51
    v_and_b32 v47, 0xffff0000, v51
    v_max_f32 v48, 0, v154
    v_max_f32 v49, 0, v155
    v_pk_add_f32 v[46:47], v[46:47], v[48:49]
    v_cvt_pk_bf16_f32 v51, v46, v47
    v_lshlrev_b32 v46, 16, v51
    v_and_b32 v47, 0xffff0000, v51
    v_pk_mul_f32 v[46:47], v[46:47], s[48:49] op_sel_hi:[1,0]
    v_exp_f32 v46, v46
    v_exp_f32 v47, v47
    s_nop 0
    v_pk_add_f32 v[46:47], v[46:47], 1.0
    v_rcp_f32 v46, v46
    v_rcp_f32 v47, v47
    s_nop 0
    v_pk_fma_f32 v[46:47], v[46:47], -2.0, 1.0
    v_cvt_pk_bf16_f32 v51, v46, v47
    v_lshlrev_b32 v46, 16, v51
    v_and_b32 v47, 0xffff0000, v51
    v_pk_mul_f32 v[154:155], v[154:155], v[46:47]
    v_cvt_pk_bf16_f32 v55, v154, v155
    buffer_store_dwordx2 v[54:55], v16, s[40:43], 0 offen offset:64
    s_nop 0
    v_lshlrev_b32 v44, 16, v30
    v_and_b32 v45, 0xffff0000, v30
    v_cvt_pk_bf16_f32 v51, v156, v157
    v_lshlrev_b32 v156, 16, v51
    v_and_b32 v157, 0xffff0000, v51
    v_pk_add_f32 v[156:157], v[156:157], v[44:45]
    v_cvt_pk_bf16_f32 v51, v156, v157
    v_lshlrev_b32 v156, 16, v51
    v_and_b32 v157, 0xffff0000, v51
    v_mul_f32_e64 v46, s46, |v156|
    v_mul_f32_e64 v47, s46, |v157|
    v_exp_f32 v46, v46
    v_exp_f32 v47, v47
    s_nop 0
    v_cvt_pk_bf16_f32 v51, v46, v47
    v_lshlrev_b32 v46, 16, v51
    v_and_b32 v47, 0xffff0000, v51
    v_pk_add_f32 v[48:49], v[46:47], 1.0
    v_pk_add_f32 v[52:53], v[48:49], -1.0
    v_pk_add_f32 v[46:47], v[46:47], v[52:53] neg_lo:[0,1] neg_hi:[0,1]
    v_log_f32 v48, v48
    v_log_f32 v49, v49
    s_nop 0
    v_pk_fma_f32 v[46:47], v[48:49], s[50:51], v[46:47] op_sel_hi:[1,0,1]
    v_cvt_pk_bf16_f32 v51, v46, v47
    v_lshlrev_b32 v46, 16, v51
    v_and_b32 v47, 0xffff0000, v51
    v_max_f32 v48, 0, v156
    v_max_f32 v49, 0, v157
    v_pk_add_f32 v[46:47], v[46:47], v[48:49]
    v_cvt_pk_bf16_f32 v51, v46, v47
    v_lshlrev_b32 v46, 16, v51
    v_and_b32 v47, 0xffff0000, v51
    v_pk_mul_f32 v[46:47], v[46:47], s[48:49] op_sel_hi:[1,0]
    v_exp_f32 v46, v46
    v_exp_f32 v47, v47
    s_nop 0
    v_pk_add_f32 v[46:47], v[46:47], 1.0
    v_rcp_f32 v46, v46
    v_rcp_f32 v47, v47
    s_nop 0
    v_pk_fma_f32 v[46:47], v[46:47], -2.0, 1.0
    v_cvt_pk_bf16_f32 v51, v46, v47
    v_lshlrev_b32 v46, 16, v51
    v_and_b32 v47, 0xffff0000, v51
    v_pk_mul_f32 v[156:157], v[156:157], v[46:47]
    v_cvt_pk_bf16_f32 v54, v156, v157
    v_lshlrev_b32 v44, 16, v31
    v_and_b32 v45, 0xffff0000, v31
    v_cvt_pk_bf16_f32 v51, v158, v159
    v_lshlrev_b32 v158, 16, v51
    v_and_b32 v159, 0xffff0000, v51
    v_pk_add_f32 v[158:159], v[158:159], v[44:45]
    v_cvt_pk_bf16_f32 v51, v158, v159
    v_lshlrev_b32 v158, 16, v51
    v_and_b32 v159, 0xffff0000, v51
    v_mul_f32_e64 v46, s46, |v158|
    v_mul_f32_e64 v47, s46, |v159|
    v_exp_f32 v46, v46
    v_exp_f32 v47, v47
    s_nop 0
    v_cvt_pk_bf16_f32 v51, v46, v47
    v_lshlrev_b32 v46, 16, v51
    v_and_b32 v47, 0xffff0000, v51
    v_pk_add_f32 v[48:49], v[46:47], 1.0
    v_pk_add_f32 v[52:53], v[48:49], -1.0
    v_pk_add_f32 v[46:47], v[46:47], v[52:53] neg_lo:[0,1] neg_hi:[0,1]
    v_log_f32 v48, v48
    v_log_f32 v49, v49
    s_nop 0
    v_pk_fma_f32 v[46:47], v[48:49], s[50:51], v[46:47] op_sel_hi:[1,0,1]
    v_cvt_pk_bf16_f32 v51, v46, v47
    v_lshlrev_b32 v46, 16, v51
    v_and_b32 v47, 0xffff0000, v51
    v_max_f32 v48, 0, v158
    v_max_f32 v49, 0, v159
    v_pk_add_f32 v[46:47], v[46:47], v[48:49]
    v_cvt_pk_bf16_f32 v51, v46, v47
    v_lshlrev_b32 v46, 16, v51
    v_and_b32 v47, 0xffff0000, v51
    v_pk_mul_f32 v[46:47], v[46:47], s[48:49] op_sel_hi:[1,0]
    v_exp_f32 v46, v46
    v_exp_f32 v47, v47
    s_nop 0
    v_pk_add_f32 v[46:47], v[46:47], 1.0
    v_rcp_f32 v46, v46
    v_rcp_f32 v47, v47
    s_nop 0
    v_pk_fma_f32 v[46:47], v[46:47], -2.0, 1.0
    v_cvt_pk_bf16_f32 v51, v46, v47
    v_lshlrev_b32 v46, 16, v51
    v_and_b32 v47, 0xffff0000, v51
    v_pk_mul_f32 v[158:159], v[158:159], v[46:47]
    v_cvt_pk_bf16_f32 v55, v158, v159
    buffer_store_dwordx2 v[54:55], v16, s[40:43], 0 offen offset:80
    s_nop 0
    v_lshlrev_b32 v44, 16, v32
    v_and_b32 v45, 0xffff0000, v32
    v_cvt_pk_bf16_f32 v51, v160, v161
    v_lshlrev_b32 v160, 16, v51
    v_and_b32 v161, 0xffff0000, v51
    v_pk_add_f32 v[160:161], v[160:161], v[44:45]
    v_cvt_pk_bf16_f32 v51, v160, v161
    v_lshlrev_b32 v160, 16, v51
    v_and_b32 v161, 0xffff0000, v51
    v_mul_f32_e64 v46, s46, |v160|
    v_mul_f32_e64 v47, s46, |v161|
    v_exp_f32 v46, v46
    v_exp_f32 v47, v47
    s_nop 0
    v_cvt_pk_bf16_f32 v51, v46, v47
    v_lshlrev_b32 v46, 16, v51
    v_and_b32 v47, 0xffff0000, v51
    v_pk_add_f32 v[48:49], v[46:47], 1.0
    v_pk_add_f32 v[52:53], v[48:49], -1.0
    v_pk_add_f32 v[46:47], v[46:47], v[52:53] neg_lo:[0,1] neg_hi:[0,1]
    v_log_f32 v48, v48
    v_log_f32 v49, v49
    s_nop 0
    v_pk_fma_f32 v[46:47], v[48:49], s[50:51], v[46:47] op_sel_hi:[1,0,1]
    v_cvt_pk_bf16_f32 v51, v46, v47
    v_lshlrev_b32 v46, 16, v51
    v_and_b32 v47, 0xffff0000, v51
    v_max_f32 v48, 0, v160
    v_max_f32 v49, 0, v161
    v_pk_add_f32 v[46:47], v[46:47], v[48:49]
    v_cvt_pk_bf16_f32 v51, v46, v47
    v_lshlrev_b32 v46, 16, v51
    v_and_b32 v47, 0xffff0000, v51
    v_pk_mul_f32 v[46:47], v[46:47], s[48:49] op_sel_hi:[1,0]
    v_exp_f32 v46, v46
    v_exp_f32 v47, v47
    s_nop 0
    v_pk_add_f32 v[46:47], v[46:47], 1.0
    v_rcp_f32 v46, v46
    v_rcp_f32 v47, v47
    s_nop 0
    v_pk_fma_f32 v[46:47], v[46:47], -2.0, 1.0
    v_cvt_pk_bf16_f32 v51, v46, v47
    v_lshlrev_b32 v46, 16, v51
    v_and_b32 v47, 0xffff0000, v51
    v_pk_mul_f32 v[160:161], v[160:161], v[46:47]
    v_cvt_pk_bf16_f32 v54, v160, v161
    v_lshlrev_b32 v44, 16, v33
    v_and_b32 v45, 0xffff0000, v33
    v_cvt_pk_bf16_f32 v51, v162, v163
    v_lshlrev_b32 v162, 16, v51
    v_and_b32 v163, 0xffff0000, v51
    v_pk_add_f32 v[162:163], v[162:163], v[44:45]
    v_cvt_pk_bf16_f32 v51, v162, v163
    v_lshlrev_b32 v162, 16, v51
    v_and_b32 v163, 0xffff0000, v51
    v_mul_f32_e64 v46, s46, |v162|
    v_mul_f32_e64 v47, s46, |v163|
    v_exp_f32 v46, v46
    v_exp_f32 v47, v47
    s_nop 0
    v_cvt_pk_bf16_f32 v51, v46, v47
    v_lshlrev_b32 v46, 16, v51
    v_and_b32 v47, 0xffff0000, v51
    v_pk_add_f32 v[48:49], v[46:47], 1.0
    v_pk_add_f32 v[52:53], v[48:49], -1.0
    v_pk_add_f32 v[46:47], v[46:47], v[52:53] neg_lo:[0,1] neg_hi:[0,1]
    v_log_f32 v48, v48
    v_log_f32 v49, v49
    s_nop 0
    v_pk_fma_f32 v[46:47], v[48:49], s[50:51], v[46:47] op_sel_hi:[1,0,1]
    v_cvt_pk_bf16_f32 v51, v46, v47
    v_lshlrev_b32 v46, 16, v51
    v_and_b32 v47, 0xffff0000, v51
    v_max_f32 v48, 0, v162
    v_max_f32 v49, 0, v163
    v_pk_add_f32 v[46:47], v[46:47], v[48:49]
    v_cvt_pk_bf16_f32 v51, v46, v47
    v_lshlrev_b32 v46, 16, v51
    v_and_b32 v47, 0xffff0000, v51
    v_pk_mul_f32 v[46:47], v[46:47], s[48:49] op_sel_hi:[1,0]
    v_exp_f32 v46, v46
    v_exp_f32 v47, v47
    s_nop 0
    v_pk_add_f32 v[46:47], v[46:47], 1.0
    v_rcp_f32 v46, v46
    v_rcp_f32 v47, v47
    s_nop 0
    v_pk_fma_f32 v[46:47], v[46:47], -2.0, 1.0
    v_cvt_pk_bf16_f32 v51, v46, v47
    v_lshlrev_b32 v46, 16, v51
    v_and_b32 v47, 0xffff0000, v51
    v_pk_mul_f32 v[162:163], v[162:163], v[46:47]
    v_cvt_pk_bf16_f32 v55, v162, v163
    buffer_store_dwordx2 v[54:55], v16, s[40:43], 0 offen offset:96
    s_nop 0
    v_lshlrev_b32 v44, 16, v34
    v_and_b32 v45, 0xffff0000, v34
    v_cvt_pk_bf16_f32 v51, v164, v165
    v_lshlrev_b32 v164, 16, v51
    v_and_b32 v165, 0xffff0000, v51
    v_pk_add_f32 v[164:165], v[164:165], v[44:45]
    v_cvt_pk_bf16_f32 v51, v164, v165
    v_lshlrev_b32 v164, 16, v51
    v_and_b32 v165, 0xffff0000, v51
    v_mul_f32_e64 v46, s46, |v164|
    v_mul_f32_e64 v47, s46, |v165|
    v_exp_f32 v46, v46
    v_exp_f32 v47, v47
    s_nop 0
    v_cvt_pk_bf16_f32 v51, v46, v47
    v_lshlrev_b32 v46, 16, v51
    v_and_b32 v47, 0xffff0000, v51
    v_pk_add_f32 v[48:49], v[46:47], 1.0
    v_pk_add_f32 v[52:53], v[48:49], -1.0
    v_pk_add_f32 v[46:47], v[46:47], v[52:53] neg_lo:[0,1] neg_hi:[0,1]
    v_log_f32 v48, v48
    v_log_f32 v49, v49
    s_nop 0
    v_pk_fma_f32 v[46:47], v[48:49], s[50:51], v[46:47] op_sel_hi:[1,0,1]
    v_cvt_pk_bf16_f32 v51, v46, v47
    v_lshlrev_b32 v46, 16, v51
    v_and_b32 v47, 0xffff0000, v51
    v_max_f32 v48, 0, v164
    v_max_f32 v49, 0, v165
    v_pk_add_f32 v[46:47], v[46:47], v[48:49]
    v_cvt_pk_bf16_f32 v51, v46, v47
    v_lshlrev_b32 v46, 16, v51
    v_and_b32 v47, 0xffff0000, v51
    v_pk_mul_f32 v[46:47], v[46:47], s[48:49] op_sel_hi:[1,0]
    v_exp_f32 v46, v46
    v_exp_f32 v47, v47
    s_nop 0
    v_pk_add_f32 v[46:47], v[46:47], 1.0
    v_rcp_f32 v46, v46
    v_rcp_f32 v47, v47
    s_nop 0
    v_pk_fma_f32 v[46:47], v[46:47], -2.0, 1.0
    v_cvt_pk_bf16_f32 v51, v46, v47
    v_lshlrev_b32 v46, 16, v51
    v_and_b32 v47, 0xffff0000, v51
    v_pk_mul_f32 v[164:165], v[164:165], v[46:47]
    v_cvt_pk_bf16_f32 v54, v164, v165
    v_lshlrev_b32 v44, 16, v35
    v_and_b32 v45, 0xffff0000, v35
    v_cvt_pk_bf16_f32 v51, v166, v167
    v_lshlrev_b32 v166, 16, v51
    v_and_b32 v167, 0xffff0000, v51
    v_pk_add_f32 v[166:167], v[166:167], v[44:45]
    v_cvt_pk_bf16_f32 v51, v166, v167
    v_lshlrev_b32 v166, 16, v51
    v_and_b32 v167, 0xffff0000, v51
    v_mul_f32_e64 v46, s46, |v166|
    v_mul_f32_e64 v47, s46, |v167|
    v_exp_f32 v46, v46
    v_exp_f32 v47, v47
    s_nop 0
    v_cvt_pk_bf16_f32 v51, v46, v47
    v_lshlrev_b32 v46, 16, v51
    v_and_b32 v47, 0xffff0000, v51
    v_pk_add_f32 v[48:49], v[46:47], 1.0
    v_pk_add_f32 v[52:53], v[48:49], -1.0
    v_pk_add_f32 v[46:47], v[46:47], v[52:53] neg_lo:[0,1] neg_hi:[0,1]
    v_log_f32 v48, v48
    v_log_f32 v49, v49
    s_nop 0
    v_pk_fma_f32 v[46:47], v[48:49], s[50:51], v[46:47] op_sel_hi:[1,0,1]
    v_cvt_pk_bf16_f32 v51, v46, v47
    v_lshlrev_b32 v46, 16, v51
    v_and_b32 v47, 0xffff0000, v51
    v_max_f32 v48, 0, v166
    v_max_f32 v49, 0, v167
    v_pk_add_f32 v[46:47], v[46:47], v[48:49]
    v_cvt_pk_bf16_f32 v51, v46, v47
    v_lshlrev_b32 v46, 16, v51
    v_and_b32 v47, 0xffff0000, v51
    v_pk_mul_f32 v[46:47], v[46:47], s[48:49] op_sel_hi:[1,0]
    v_exp_f32 v46, v46
    v_exp_f32 v47, v47
    s_nop 0
    v_pk_add_f32 v[46:47], v[46:47], 1.0
    v_rcp_f32 v46, v46
    v_rcp_f32 v47, v47
    s_nop 0
    v_pk_fma_f32 v[46:47], v[46:47], -2.0, 1.0
    v_cvt_pk_bf16_f32 v51, v46, v47
    v_lshlrev_b32 v46, 16, v51
    v_and_b32 v47, 0xffff0000, v51
    v_pk_mul_f32 v[166:167], v[166:167], v[46:47]
    v_cvt_pk_bf16_f32 v55, v166, v167
    buffer_store_dwordx2 v[54:55], v16, s[40:43], 0 offen offset:112
    s_nop 0
L_g1_skip1:
    s_mul_i32 s52, s25, 96
    s_add_u32 s52, s52, s23
    s_add_u32 s52, s52, 64
    s_cmp_ge_u32 s52, 1408
    s_cbranch_scc1 L_g1_skip2
    v_lshlrev_b32 v44, 16, v36
    v_and_b32 v45, 0xffff0000, v36
    v_cvt_pk_bf16_f32 v51, v168, v169
    v_lshlrev_b32 v168, 16, v51
    v_and_b32 v169, 0xffff0000, v51
    v_pk_add_f32 v[168:169], v[168:169], v[44:45]
    v_cvt_pk_bf16_f32 v51, v168, v169
    v_lshlrev_b32 v168, 16, v51
    v_and_b32 v169, 0xffff0000, v51
    v_mul_f32_e64 v46, s46, |v168|
    v_mul_f32_e64 v47, s46, |v169|
    v_exp_f32 v46, v46
    v_exp_f32 v47, v47
    s_nop 0
    v_cvt_pk_bf16_f32 v51, v46, v47
    v_lshlrev_b32 v46, 16, v51
    v_and_b32 v47, 0xffff0000, v51
    v_pk_add_f32 v[48:49], v[46:47], 1.0
    v_pk_add_f32 v[52:53], v[48:49], -1.0
    v_pk_add_f32 v[46:47], v[46:47], v[52:53] neg_lo:[0,1] neg_hi:[0,1]
    v_log_f32 v48, v48
    v_log_f32 v49, v49
    s_nop 0
    v_pk_fma_f32 v[46:47], v[48:49], s[50:51], v[46:47] op_sel_hi:[1,0,1]
    v_cvt_pk_bf16_f32 v51, v46, v47
    v_lshlrev_b32 v46, 16, v51
    v_and_b32 v47, 0xffff0000, v51
    v_max_f32 v48, 0, v168
    v_max_f32 v49, 0, v169
    v_pk_add_f32 v[46:47], v[46:47], v[48:49]
    v_cvt_pk_bf16_f32 v51, v46, v47
    v_lshlrev_b32 v46, 16, v51
    v_and_b32 v47, 0xffff0000, v51
    v_pk_mul_f32 v[46:47], v[46:47], s[48:49] op_sel_hi:[1,0]
    v_exp_f32 v46, v46
    v_exp_f32 v47, v47
    s_nop 0
    v_pk_add_f32 v[46:47], v[46:47], 1.0
    v_rcp_f32 v46, v46
    v_rcp_f32 v47, v47
    s_nop 0
    v_pk_fma_f32 v[46:47], v[46:47], -2.0, 1.0
    v_cvt_pk_bf16_f32 v51, v46, v47
    v_lshlrev_b32 v46, 16, v51
    v_and_b32 v47, 0xffff0000, v51
    v_pk_mul_f32 v[168:169], v[168:169], v[46:47]
    v_cvt_pk_bf16_f32 v54, v168, v169
    v_lshlrev_b32 v44, 16, v37
    v_and_b32 v45, 0xffff0000, v37
    v_cvt_pk_bf16_f32 v51, v170, v171
    v_lshlrev_b32 v170, 16, v51
    v_and_b32 v171, 0xffff0000, v51
    v_pk_add_f32 v[170:171], v[170:171], v[44:45]
    v_cvt_pk_bf16_f32 v51, v170, v171
    v_lshlrev_b32 v170, 16, v51
    v_and_b32 v171, 0xffff0000, v51
    v_mul_f32_e64 v46, s46, |v170|
    v_mul_f32_e64 v47, s46, |v171|
    v_exp_f32 v46, v46
    v_exp_f32 v47, v47
    s_nop 0
    v_cvt_pk_bf16_f32 v51, v46, v47
    v_lshlrev_b32 v46, 16, v51
    v_and_b32 v47, 0xffff0000, v51
    v_pk_add_f32 v[48:49], v[46:47], 1.0
    v_pk_add_f32 v[52:53], v[48:49], -1.0
    v_pk_add_f32 v[46:47], v[46:47], v[52:53] neg_lo:[0,1] neg_hi:[0,1]
    v_log_f32 v48, v48
    v_log_f32 v49, v49
    s_nop 0
    v_pk_fma_f32 v[46:47], v[48:49], s[50:51], v[46:47] op_sel_hi:[1,0,1]
    v_cvt_pk_bf16_f32 v51, v46, v47
    v_lshlrev_b32 v46, 16, v51
    v_and_b32 v47, 0xffff0000, v51
    v_max_f32 v48, 0, v170
    v_max_f32 v49, 0, v171
    v_pk_add_f32 v[46:47], v[46:47], v[48:49]
    v_cvt_pk_bf16_f32 v51, v46, v47
    v_lshlrev_b32 v46, 16, v51
    v_and_b32 v47, 0xffff0000, v51
    v_pk_mul_f32 v[46:47], v[46:47], s[48:49] op_sel_hi:[1,0]
    v_exp_f32 v46, v46
    v_exp_f32 v47, v47
    s_nop 0
    v_pk_add_f32 v[46:47], v[46:47], 1.0
    v_rcp_f32 v46, v46
    v_rcp_f32 v47, v47
    s_nop 0
    v_pk_fma_f32 v[46:47], v[46:47], -2.0, 1.0
    v_cvt_pk_bf16_f32 v51, v46, v47
    v_lshlrev_b32 v46, 16, v51
    v_and_b32 v47, 0xffff0000, v51
    v_pk_mul_f32 v[170:171], v[170:171], v[46:47]
    v_cvt_pk_bf16_f32 v55, v170, v171
    buffer_store_dwordx2 v[54:55], v16, s[40:43], 0 offen offset:128
    s_nop 0
    v_lshlrev_b32 v44, 16, v38
    v_and_b32 v45, 0xffff0000, v38
    v_cvt_pk_bf16_f32 v51, v172, v173
    v_lshlrev_b32 v172, 16, v51
    v_and_b32 v173, 0xffff0000, v51
    v_pk_add_f32 v[172:173], v[172:173], v[44:45]
    v_cvt_pk_bf16_f32 v51, v172, v173
    v_lshlrev_b32 v172, 16, v51
    v_and_b32 v173, 0xffff0000, v51
    v_mul_f32_e64 v46, s46, |v172|
    v_mul_f32_e64 v47, s46, |v173|
    v_exp_f32 v46, v46
    v_exp_f32 v47, v47
    s_nop 0
    v_cvt_pk_bf16_f32 v51, v46, v47
    v_lshlrev_b32 v46, 16, v51
    v_and_b32 v47, 0xffff0000, v51
    v_pk_add_f32 v[48:49], v[46:47], 1.0
    v_pk_add_f32 v[52:53], v[48:49], -1.0
    v_pk_add_f32 v[46:47], v[46:47], v[52:53] neg_lo:[0,1] neg_hi:[0,1]
    v_log_f32 v48, v48
    v_log_f32 v49, v49
    s_nop 0
    v_pk_fma_f32 v[46:47], v[48:49], s[50:51], v[46:47] op_sel_hi:[1,0,1]
    v_cvt_pk_bf16_f32 v51, v46, v47
    v_lshlrev_b32 v46, 16, v51
    v_and_b32 v47, 0xffff0000, v51
    v_max_f32 v48, 0, v172
    v_max_f32 v49, 0, v173
    v_pk_add_f32 v[46:47], v[46:47], v[48:49]
    v_cvt_pk_bf16_f32 v51, v46, v47
    v_lshlrev_b32 v46, 16, v51
    v_and_b32 v47, 0xffff0000, v51
    v_pk_mul_f32 v[46:47], v[46:47], s[48:49] op_sel_hi:[1,0]
    v_exp_f32 v46, v46
    v_exp_f32 v47, v47
    s_nop 0
    v_pk_add_f32 v[46:47], v[46:47], 1.0
    v_rcp_f32 v46, v46
    v_rcp_f32 v47, v47
    s_nop 0
    v_pk_fma_f32 v[46:47], v[46:47], -2.0, 1.0
    v_cvt_pk_bf16_f32 v51, v46, v47
    v_lshlrev_b32 v46, 16, v51
    v_and_b32 v47, 0xffff0000, v51
    v_pk_mul_f32 v[172:173], v[172:173], v[46:47]
    v_cvt_pk_bf16_f32 v54, v172, v173
    v_lshlrev_b32 v44, 16, v39
    v_and_b32 v45, 0xffff0000, v39
    v_cvt_pk_bf16_f32 v51, v174, v175
    v_lshlrev_b32 v174, 16, v51
    v_and_b32 v175, 0xffff0000, v51
    v_pk_add_f32 v[174:175], v[174:175], v[44:45]
    v_cvt_pk_bf16_f32 v51, v174, v175
    v_lshlrev_b32 v174, 16, v51
    v_and_b32 v175, 0xffff0000, v51
    v_mul_f32_e64 v46, s46, |v174|
    v_mul_f32_e64 v47, s46, |v175|
    v_exp_f32 v46, v46
    v_exp_f32 v47, v47
    s_nop 0
    v_cvt_pk_bf16_f32 v51, v46, v47
    v_lshlrev_b32 v46, 16, v51
    v_and_b32 v47, 0xffff0000, v51
    v_pk_add_f32 v[48:49], v[46:47], 1.0
    v_pk_add_f32 v[52:53], v[48:49], -1.0
    v_pk_add_f32 v[46:47], v[46:47], v[52:53] neg_lo:[0,1] neg_hi:[0,1]
    v_log_f32 v48, v48
    v_log_f32 v49, v49
    s_nop 0
    v_pk_fma_f32 v[46:47], v[48:49], s[50:51], v[46:47] op_sel_hi:[1,0,1]
    v_cvt_pk_bf16_f32 v51, v46, v47
    v_lshlrev_b32 v46, 16, v51
    v_and_b32 v47, 0xffff0000, v51
    v_max_f32 v48, 0, v174
    v_max_f32 v49, 0, v175
    v_pk_add_f32 v[46:47], v[46:47], v[48:49]
    v_cvt_pk_bf16_f32 v51, v46, v47
    v_lshlrev_b32 v46, 16, v51
    v_and_b32 v47, 0xffff0000, v51
    v_pk_mul_f32 v[46:47], v[46:47], s[48:49] op_sel_hi:[1,0]
    v_exp_f32 v46, v46
    v_exp_f32 v47, v47
    s_nop 0
    v_pk_add_f32 v[46:47], v[46:47], 1.0
    v_rcp_f32 v46, v46
    v_rcp_f32 v47, v47
    s_nop 0
    v_pk_fma_f32 v[46:47], v[46:47], -2.0, 1.0
    v_cvt_pk_bf16_f32 v51, v46, v47
    v_lshlrev_b32 v46, 16, v51
    v_and_b32 v47, 0xffff0000, v51
    v_pk_mul_f32 v[174:175], v[174:175], v[46:47]
    v_cvt_pk_bf16_f32 v55, v174, v175
    buffer_store_dwordx2 v[54:55], v16, s[40:43], 0 offen offset:144
    s_nop 0
    v_lshlrev_b32 v44, 16, v40
    v_and_b32 v45, 0xffff0000, v40
    v_cvt_pk_bf16_f32 v51, v176, v177
    v_lshlrev_b32 v176, 16, v51
    v_and_b32 v177, 0xffff0000, v51
    v_pk_add_f32 v[176:177], v[176:177], v[44:45]
    v_cvt_pk_bf16_f32 v51, v176, v177
    v_lshlrev_b32 v176, 16, v51
    v_and_b32 v177, 0xffff0000, v51
    v_mul_f32_e64 v46, s46, |v176|
    v_mul_f32_e64 v47, s46, |v177|
    v_exp_f32 v46, v46
    v_exp_f32 v47, v47
    s_nop 0
    v_cvt_pk_bf16_f32 v51, v46, v47
    v_lshlrev_b32 v46, 16, v51
    v_and_b32 v47, 0xffff0000, v51
    v_pk_add_f32 v[48:49], v[46:47], 1.0
    v_pk_add_f32 v[52:53], v[48:49], -1.0
    v_pk_add_f32 v[46:47], v[46:47], v[52:53] neg_lo:[0,1] neg_hi:[0,1]
    v_log_f32 v48, v48
    v_log_f32 v49, v49
    s_nop 0
    v_pk_fma_f32 v[46:47], v[48:49], s[50:51], v[46:47] op_sel_hi:[1,0,1]
    v_cvt_pk_bf16_f32 v51, v46, v47
    v_lshlrev_b32 v46, 16, v51
    v_and_b32 v47, 0xffff0000, v51
    v_max_f32 v48, 0, v176
    v_max_f32 v49, 0, v177
    v_pk_add_f32 v[46:47], v[46:47], v[48:49]
    v_cvt_pk_bf16_f32 v51, v46, v47
    v_lshlrev_b32 v46, 16, v51
    v_and_b32 v47, 0xffff0000, v51
    v_pk_mul_f32 v[46:47], v[46:47], s[48:49] op_sel_hi:[1,0]
    v_exp_f32 v46, v46
    v_exp_f32 v47, v47
    s_nop 0
    v_pk_add_f32 v[46:47], v[46:47], 1.0
    v_rcp_f32 v46, v46
    v_rcp_f32 v47, v47
    s_nop 0
    v_pk_fma_f32 v[46:47], v[46:47], -2.0, 1.0
    v_cvt_pk_bf16_f32 v51, v46, v47
    v_lshlrev_b32 v46, 16, v51
    v_and_b32 v47, 0xffff0000, v51
    v_pk_mul_f32 v[176:177], v[176:177], v[46:47]
    v_cvt_pk_bf16_f32 v54, v176, v177
    v_lshlrev_b32 v44, 16, v41
    v_and_b32 v45, 0xffff0000, v41
    v_cvt_pk_bf16_f32 v51, v178, v179
    v_lshlrev_b32 v178, 16, v51
    v_and_b32 v179, 0xffff0000, v51
    v_pk_add_f32 v[178:179], v[178:179], v[44:45]
    v_cvt_pk_bf16_f32 v51, v178, v179
    v_lshlrev_b32 v178, 16, v51
    v_and_b32 v179, 0xffff0000, v51
    v_mul_f32_e64 v46, s46, |v178|
    v_mul_f32_e64 v47, s46, |v179|
    v_exp_f32 v46, v46
    v_exp_f32 v47, v47
    s_nop 0
    v_cvt_pk_bf16_f32 v51, v46, v47
    v_lshlrev_b32 v46, 16, v51
    v_and_b32 v47, 0xffff0000, v51
    v_pk_add_f32 v[48:49], v[46:47], 1.0
    v_pk_add_f32 v[52:53], v[48:49], -1.0
    v_pk_add_f32 v[46:47], v[46:47], v[52:53] neg_lo:[0,1] neg_hi:[0,1]
    v_log_f32 v48, v48
    v_log_f32 v49, v49
    s_nop 0
    v_pk_fma_f32 v[46:47], v[48:49], s[50:51], v[46:47] op_sel_hi:[1,0,1]
    v_cvt_pk_bf16_f32 v51, v46, v47
    v_lshlrev_b32 v46, 16, v51
    v_and_b32 v47, 0xffff0000, v51
    v_max_f32 v48, 0, v178
    v_max_f32 v49, 0, v179
    v_pk_add_f32 v[46:47], v[46:47], v[48:49]
    v_cvt_pk_bf16_f32 v51, v46, v47
    v_lshlrev_b32 v46, 16, v51
    v_and_b32 v47, 0xffff0000, v51
    v_pk_mul_f32 v[46:47], v[46:47], s[48:49] op_sel_hi:[1,0]
    v_exp_f32 v46, v46
    v_exp_f32 v47, v47
    s_nop 0
    v_pk_add_f32 v[46:47], v[46:47], 1.0
    v_rcp_f32 v46, v46
    v_rcp_f32 v47, v47
    s_nop 0
    v_pk_fma_f32 v[46:47], v[46:47], -2.0, 1.0
    v_cvt_pk_bf16_f32 v51, v46, v47
    v_lshlrev_b32 v46, 16, v51
    v_and_b32 v47, 0xffff0000, v51
    v_pk_mul_f32 v[178:179], v[178:179], v[46:47]
    v_cvt_pk_bf16_f32 v55, v178, v179
    buffer_store_dwordx2 v[54:55], v16, s[40:43], 0 offen offset:160
    s_nop 0
    v_lshlrev_b32 v44, 16, v42
    v_and_b32 v45, 0xffff0000, v42
    v_cvt_pk_bf16_f32 v51, v180, v181
    v_lshlrev_b32 v180, 16, v51
    v_and_b32 v181, 0xffff0000, v51
    v_pk_add_f32 v[180:181], v[180:181], v[44:45]
    v_cvt_pk_bf16_f32 v51, v180, v181
    v_lshlrev_b32 v180, 16, v51
    v_and_b32 v181, 0xffff0000, v51
    v_mul_f32_e64 v46, s46, |v180|
    v_mul_f32_e64 v47, s46, |v181|
    v_exp_f32 v46, v46
    v_exp_f32 v47, v47
    s_nop 0
    v_cvt_pk_bf16_f32 v51, v46, v47
    v_lshlrev_b32 v46, 16, v51
    v_and_b32 v47, 0xffff0000, v51
    v_pk_add_f32 v[48:49], v[46:47], 1.0
    v_pk_add_f32 v[52:53], v[48:49], -1.0
    v_pk_add_f32 v[46:47], v[46:47], v[52:53] neg_lo:[0,1] neg_hi:[0,1]
    v_log_f32 v48, v48
    v_log_f32 v49, v49
    s_nop 0
    v_pk_fma_f32 v[46:47], v[48:49], s[50:51], v[46:47] op_sel_hi:[1,0,1]
    v_cvt_pk_bf16_f32 v51, v46, v47
    v_lshlrev_b32 v46, 16, v51
    v_and_b32 v47, 0xffff0000, v51
    v_max_f32 v48, 0, v180
    v_max_f32 v49, 0, v181
    v_pk_add_f32 v[46:47], v[46:47], v[48:49]
    v_cvt_pk_bf16_f32 v51, v46, v47
    v_lshlrev_b32 v46, 16, v51
    v_and_b32 v47, 0xffff0000, v51
    v_pk_mul_f32 v[46:47], v[46:47], s[48:49] op_sel_hi:[1,0]
    v_exp_f32 v46, v46
    v_exp_f32 v47, v47
    s_nop 0
    v_pk_add_f32 v[46:47], v[46:47], 1.0
    v_rcp_f32 v46, v46
    v_rcp_f32 v47, v47
    s_nop 0
    v_pk_fma_f32 v[46:47], v[46:47], -2.0, 1.0
    v_cvt_pk_bf16_f32 v51, v46, v47
    v_lshlrev_b32 v46, 16, v51
    v_and_b32 v47, 0xffff0000, v51
    v_pk_mul_f32 v[180:181], v[180:181], v[46:47]
    v_cvt_pk_bf16_f32 v54, v180, v181
    v_lshlrev_b32 v44, 16, v43
    v_and_b32 v45, 0xffff0000, v43
    v_cvt_pk_bf16_f32 v51, v182, v183
    v_lshlrev_b32 v182, 16, v51
    v_and_b32 v183, 0xffff0000, v51
    v_pk_add_f32 v[182:183], v[182:183], v[44:45]
    v_cvt_pk_bf16_f32 v51, v182, v183
    v_lshlrev_b32 v182, 16, v51
    v_and_b32 v183, 0xffff0000, v51
    v_mul_f32_e64 v46, s46, |v182|
    v_mul_f32_e64 v47, s46, |v183|
    v_exp_f32 v46, v46
    v_exp_f32 v47, v47
    s_nop 0
    v_cvt_pk_bf16_f32 v51, v46, v47
    v_lshlrev_b32 v46, 16, v51
    v_and_b32 v47, 0xffff0000, v51
    v_pk_add_f32 v[48:49], v[46:47], 1.0
    v_pk_add_f32 v[52:53], v[48:49], -1.0
    v_pk_add_f32 v[46:47], v[46:47], v[52:53] neg_lo:[0,1] neg_hi:[0,1]
    v_log_f32 v48, v48
    v_log_f32 v49, v49
    s_nop 0
    v_pk_fma_f32 v[46:47], v[48:49], s[50:51], v[46:47] op_sel_hi:[1,0,1]
    v_cvt_pk_bf16_f32 v51, v46, v47
    v_lshlrev_b32 v46, 16, v51
    v_and_b32 v47, 0xffff0000, v51
    v_max_f32 v48, 0, v182
    v_max_f32 v49, 0, v183
    v_pk_add_f32 v[46:47], v[46:47], v[48:49]
    v_cvt_pk_bf16_f32 v51, v46, v47
    v_lshlrev_b32 v46, 16, v51
    v_and_b32 v47, 0xffff0000, v51
    v_pk_mul_f32 v[46:47], v[46:47], s[48:49] op_sel_hi:[1,0]
    v_exp_f32 v46, v46
    v_exp_f32 v47, v47
    s_nop 0
    v_pk_add_f32 v[46:47], v[46:47], 1.0
    v_rcp_f32 v46, v46
    v_rcp_f32 v47, v47
    s_nop 0
    v_pk_fma_f32 v[46:47], v[46:47], -2.0, 1.0
    v_cvt_pk_bf16_f32 v51, v46, v47
    v_lshlrev_b32 v46, 16, v51
    v_and_b32 v47, 0xffff0000, v51
    v_pk_mul_f32 v[182:183], v[182:183], v[46:47]
    v_cvt_pk_bf16_f32 v55, v182, v183
    buffer_store_dwordx2 v[54:55], v16, s[40:43], 0 offen offset:176
    s_nop 0
L_g1_skip2:
L_k1_done:
    s_endpgm
.globl gemm2_kernel
.p2align 8
.type gemm2_kernel,@function
gemm2_kernel:
    v_readfirstlane_b32 s3, v0
    s_lshr_b32 s3, s3, 6
    v_and_b32 v1, 63, v0
    s_load_dwordx2 s[4:5], s[0:1], 104
    s_load_dwordx2 s[6:7], s[0:1], 0
    s_load_dwordx2 s[8:9], s[0:1], 88
    s_cmp_ge_u32 s2, 256
    s_cbranch_scc1 L_k2_done
    s_lshr_b32 s20, s2, 5
    s_and_b32 s21, s2, 7
    s_lshl_b32 s21, s21, 2
    s_lshr_b32 s45, s2, 3
    s_and_b32 s45, s45, 3
    s_add_u32 s21, s21, s45
    s_lshl_b32 s22, s20, 6
    s_lshl_b32 s23, s21, 6
    s_lshr_b32 s24, s3, 1
    s_and_b32 s25, s3, 1
    v_and_b32 v2, 31, v1
    v_lshrrev_b32 v3, 5, v1
    v_lshrrev_b32 v4, 3, v0
    v_and_b32 v5, 7, v0
    v_lshlrev_b32 v6, 4, v5
    s_waitcnt lgkmcnt(0)
    s_mov_b32 s28, s6
    s_mov_b32 s29, s7
    s_mov_b32 s30, 0x200000
    s_mov_b32 s31, 0x00020000
    s_mov_b32 s32, s8
    s_mov_b32 s33, s9
    s_mov_b32 s34, 0x200000
    s_mov_b32 s35, 0x00020000
    s_mov_b32 s40, s4
    s_mov_b32 s41, s5
    s_mov_b32 s42, 0x10000000
    s_mov_b32 s43, 0x00020000
    s_movk_i32 s44, 2816
    v_add_u32 v7, s22, v4
    v_mul_lo_u32 v7, v7, s44
    v_add_u32 v7, v7, v6
    v_add_u32 v8, 0x700000, v7
    v_add_u32 v9, 90112, v8
    v_add_u32 v7, s23, v4
    v_mul_lo_u32 v7, v7, s44
    v_add_u32 v7, v7, v6
    v_add_u32 v10, 0x900000, v7
    v_add_u32 v11, 90112, v10
    v_mul_u32_u24 v12, 144, v4
    v_add_u32 v12, v12, v6
    s_lshl_b32 s26, s24, 5
    v_add_u32 v13, s26, v2
    v_mul_u32_u24 v13, 144, v13
    v_lshlrev_b32 v7, 4, v3
    v_add_u32 v13, v13, v7
    s_lshl_b32 s27, s25, 5
    v_add_u32 v14, s27, v2
    v_mul_u32_u24 v14, 144, v14
    v_add_u32 v14, v14, v7
    v_add_u32 v14, 9216, v14
    s_add_u32 s27, s23, s27
    v_add_u32 v17, s27, v2
    s_add_u32 s26, s22, s26
    v_lshlrev_b32 v7, 2, v3
    v_add_u32 v7, s26, v7
    v_lshlrev_b32 v15, 10, v17
    v_lshl_add_u32 v15, v7, 1, v15
    v_lshlrev_b32 v16, 12, v7
    v_lshl_add_u32 v16, v17, 1, v16
    v_add_u32 v16, 0x200000, v16
    v_lshlrev_b32 v18, 2, v17
    v_add_u32 v18, 0x400000, v18
    s_mov_b32 s45, 0
    buffer_load_ushort v20, v16, s[40:43], s45 offen
    s_mov_b32 s45, 4096
    buffer_load_ushort v21, v16, s[40:43], s45 offen
    s_mov_b32 s45, 8192
    buffer_load_ushort v22, v16, s[40:43], s45 offen
    s_mov_b32 s45, 12288
    buffer_load_ushort v23, v16, s[40:43], s45 offen
    s_mov_b32 s45, 32768
    buffer_load_ushort v24, v16, s[40:43], s45 offen
    s_mov_b32 s45, 36864
    buffer_load_ushort v25, v16, s[40:43], s45 offen
    s_mov_b32 s45, 40960
    buffer_load_ushort v26, v16, s[40:43], s45 offen
    s_mov_b32 s45, 45056
    buffer_load_ushort v27, v16, s[40:43], s45 offen
    s_mov_b32 s45, 65536
    buffer_load_ushort v28, v16, s[40:43], s45 offen
    s_mov_b32 s45, 69632
    buffer_load_ushort v29, v16, s[40:43], s45 offen
    s_mov_b32 s45, 73728
    buffer_load_ushort v30, v16, s[40:43], s45 offen
    s_mov_b32 s45, 77824
    buffer_load_ushort v31, v16, s[40:43], s45 offen
    s_mov_b32 s45, 98304
    buffer_load_ushort v32, v16, s[40:43], s45 offen
    s_mov_b32 s45, 102400
    buffer_load_ushort v33, v16, s[40:43], s45 offen
    s_mov_b32 s45, 106496
    buffer_load_ushort v34, v16, s[40:43], s45 offen
    s_mov_b32 s45, 110592
    buffer_load_ushort v35, v16, s[40:43], s45 offen
    buffer_load_dwordx2 v[36:37], v15, s[28:31], 0 offen offset:0
    buffer_load_dwordx2 v[38:39], v15, s[28:31], 0 offen offset:16
    buffer_load_dwordx2 v[40:41], v15, s[28:31], 0 offen offset:32
    buffer_load_dwordx2 v[42:43], v15, s[28:31], 0 offen offset:48
    buffer_load_dword v44, v18, s[40:43], 0 offen
    v_mov_b32 v160, 0
    v_mov_b32 v161, 0
    v_mov_b32 v162, 0
    v_mov_b32 v163, 0
    v_mov_b32 v164, 0
    v_mov_b32 v165, 0
    v_mov_b32 v166, 0
    v_mov_b32 v167, 0
    v_mov_b32 v168, 0
    v_mov_b32 v169, 0
    v_mov_b32 v170, 0
    v_mov_b32 v171, 0
    v_mov_b32 v172, 0
    v_mov_b32 v173, 0
    v_mov_b32 v174, 0
    v_mov_b32 v175, 0
    buffer_load_dwordx4 v[48:51], v8, s[40:43], 0 offen offset:0
    buffer_load_dwordx4 v[52:55], v9, s[40:43], 0 offen offset:0
    buffer_load_dwordx4 v[56:59], v10, s[40:43], 0 offen offset:0
    buffer_load_dwordx4 v[60:63], v11, s[40:43], 0 offen offset:0
    buffer_load_dwordx4 v[64:67], v8, s[40:43], 0 offen offset:128
    buffer_load_dwordx4 v[68:71], v9, s[40:43], 0 offen offset:128
    buffer_load_dwordx4 v[72:75], v10, s[40:43], 0 offen offset:128
    buffer_load_dwordx4 v[76:79], v11, s[40:43], 0 offen offset:128
    buffer_load_dwordx4 v[80:83], v8, s[40:43], 0 offen offset:256
    buffer_load_dwordx4 v[84:87], v9, s[40:43], 0 offen offset:256
    buffer_load_dwordx4 v[88:91], v10, s[40:43], 0 offen offset:256
    buffer_load_dwordx4 v[92:95], v11, s[40:43], 0 offen offset:256
    buffer_load_dwordx4 v[96:99], v8, s[40:43], 0 offen offset:384
    buffer_load_dwordx4 v[100:103], v9, s[40:43], 0 offen offset:384
    buffer_load_dwordx4 v[104:107], v10, s[40:43], 0 offen offset:384
    buffer_load_dwordx4 v[108:111], v11, s[40:43], 0 offen offset:384
    buffer_load_dwordx4 v[112:115], v8, s[40:43], 0 offen offset:512
    buffer_load_dwordx4 v[116:119], v9, s[40:43], 0 offen offset:512
    buffer_load_dwordx4 v[120:123], v10, s[40:43], 0 offen offset:512
    buffer_load_dwordx4 v[124:127], v11, s[40:43], 0 offen offset:512
    buffer_load_dwordx4 v[128:131], v8, s[40:43], 0 offen offset:640
    buffer_load_dwordx4 v[132:135], v9, s[40:43], 0 offen offset:640
    buffer_load_dwordx4 v[136:139], v10, s[40:43], 0 offen offset:640
    buffer_load_dwordx4 v[140:143], v11, s[40:43], 0 offen offset:640
    s_waitcnt vmcnt(20)
    ds_write_b128 v12, v[48:51] offset:0
    ds_write_b128 v12, v[52:55] offset:4608
    ds_write_b128 v12, v[56:59] offset:9216
    ds_write_b128 v12, v[60:63] offset:13824
    buffer_load_dwordx4 v[48:51], v8, s[40:43], 0 offen offset:768
    buffer_load_dwordx4 v[52:55], v9, s[40:43], 0 offen offset:768
    buffer_load_dwordx4 v[56:59], v10, s[40:43], 0 offen offset:768
    buffer_load_dwordx4 v[60:63], v11, s[40:43], 0 offen offset:768
    s_waitcnt vmcnt(20)
    ds_write_b128 v12, v[64:67] offset:18432
    ds_write_b128 v12, v[68:71] offset:23040
    ds_write_b128 v12, v[72:75] offset:27648
    ds_write_b128 v12, v[76:79] offset:32256
    buffer_load_dwordx4 v[64:67], v8, s[40:43], 0 offen offset:896
    buffer_load_dwordx4 v[68:71], v9, s[40:43], 0 offen offset:896
    buffer_load_dwordx4 v[72:75], v10, s[40:43], 0 offen offset:896
    buffer_load_dwordx4 v[76:79], v11, s[40:43], 0 offen offset:896
    s_waitcnt lgkmcnt(0)
    s_barrier
    ds_read_b128 v[144:147], v13 offset:0
    ds_read_b128 v[148:151], v14 offset:0
    s_waitcnt vmcnt(20)
    ds_write_b128 v12, v[80:83] offset:36864
    ds_write_b128 v12, v[84:87] offset:41472
    ds_write_b128 v12, v[88:91] offset:46080
    ds_write_b128 v12, v[92:95] offset:50688
    buffer_load_dwordx4 v[80:83], v8, s[40:43], 0 offen offset:1024
    buffer_load_dwordx4 v[84:87], v9, s[40:43], 0 offen offset:1024
    buffer_load_dwordx4 v[88:91], v10, s[40:43], 0 offen offset:1024
    buffer_load_dwordx4 v[92:95], v11, s[40:43], 0 offen offset:1024
    ds_read_b128 v[152:155], v13 offset:32
    ds_read_b128 v[156:159], v14 offset:32
    s_waitcnt lgkmcnt(2)
    v_mfma_f32_32x32x16_bf16 v[160:175], v[144:147], v[148:151], v[160:175]
    ds_read_b128 v[144:147], v13 offset:64
    ds_read_b128 v[148:151], v14 offset:64
    s_waitcnt lgkmcnt(2)
    v_mfma_f32_32x32x16_bf16 v[160:175], v[152:155], v[156:159], v[160:175]
    ds_read_b128 v[152:155], v13 offset:96
    ds_read_b128 v[156:159], v14 offset:96
    s_waitcnt lgkmcnt(2)
    v_mfma_f32_32x32x16_bf16 v[160:175], v[144:147], v[148:151], v[160:175]
    ds_read_b128 v[144:147], v13 offset:18432
    ds_read_b128 v[148:151], v14 offset:18432
    s_waitcnt lgkmcnt(2)
    v_mfma_f32_32x32x16_bf16 v[160:175], v[152:155], v[156:159], v[160:175]
    s_barrier
    s_waitcnt vmcnt(20)
    ds_write_b128 v12, v[96:99] offset:0
    ds_write_b128 v12, v[100:103] offset:4608
    ds_write_b128 v12, v[104:107] offset:9216
    ds_write_b128 v12, v[108:111] offset:13824
    buffer_load_dwordx4 v[96:99], v8, s[40:43], 0 offen offset:1152
    buffer_load_dwordx4 v[100:103], v9, s[40:43], 0 offen offset:1152
    buffer_load_dwordx4 v[104:107], v10, s[40:43], 0 offen offset:1152
    buffer_load_dwordx4 v[108:111], v11, s[40:43], 0 offen offset:1152
    ds_read_b128 v[152:155], v13 offset:18464
    ds_read_b128 v[156:159], v14 offset:18464
    s_waitcnt lgkmcnt(2)
    v_mfma_f32_32x32x16_bf16 v[160:175], v[144:147], v[148:151], v[160:175]
    ds_read_b128 v[144:147], v13 offset:18496
    ds_read_b128 v[148:151], v14 offset:18496
    s_waitcnt lgkmcnt(2)
    v_mfma_f32_32x32x16_bf16 v[160:175], v[152:155], v[156:159], v[160:175]
    ds_read_b128 v[152:155], v13 offset:18528
    ds_read_b128 v[156:159], v14 offset:18528
    s_waitcnt lgkmcnt(2)
    v_mfma_f32_32x32x16_bf16 v[160:175], v[144:147], v[148:151], v[160:175]
    ds_read_b128 v[144:147], v13 offset:36864
    ds_read_b128 v[148:151], v14 offset:36864
    s_waitcnt lgkmcnt(2)
    v_mfma_f32_32x32x16_bf16 v[160:175], v[152:155], v[156:159], v[160:175]
    s_barrier
    s_waitcnt vmcnt(20)
    ds_write_b128 v12, v[112:115] offset:18432
    ds_write_b128 v12, v[116:119] offset:23040
    ds_write_b128 v12, v[120:123] offset:27648
    ds_write_b128 v12, v[124:127] offset:32256
    buffer_load_dwordx4 v[112:115], v8, s[40:43], 0 offen offset:1280
    buffer_load_dwordx4 v[116:119], v9, s[40:43], 0 offen offset:1280
    buffer_load_dwordx4 v[120:123], v10, s[40:43], 0 offen offset:1280
    buffer_load_dwordx4 v[124:127], v11, s[40:43], 0 offen offset:1280
    ds_read_b128 v[152:155], v13 offset:36896
    ds_read_b128 v[156:159], v14 offset:36896
    s_waitcnt lgkmcnt(2)
    v_mfma_f32_32x32x16_bf16 v[160:175], v[144:147], v[148:151], v[160:175]
    ds_read_b128 v[144:147], v13 offset:36928
    ds_read_b128 v[148:151], v14 offset:36928
    s_waitcnt lgkmcnt(2)
    v_mfma_f32_32x32x16_bf16 v[160:175], v[152:155], v[156:159], v[160:175]
    ds_read_b128 v[152:155], v13 offset:36960
    ds_read_b128 v[156:159], v14 offset:36960
    s_waitcnt lgkmcnt(2)
    v_mfma_f32_32x32x16_bf16 v[160:175], v[144:147], v[148:151], v[160:175]
    ds_read_b128 v[144:147], v13 offset:0
    ds_read_b128 v[148:151], v14 offset:0
    s_waitcnt lgkmcnt(2)
    v_mfma_f32_32x32x16_bf16 v[160:175], v[152:155], v[156:159], v[160:175]
    s_barrier
    s_waitcnt vmcnt(20)
    ds_write_b128 v12, v[128:131] offset:36864
    ds_write_b128 v12, v[132:135] offset:41472
    ds_write_b128 v12, v[136:139] offset:46080
    ds_write_b128 v12, v[140:143] offset:50688
    buffer_load_dwordx4 v[128:131], v8, s[40:43], 0 offen offset:1408
    buffer_load_dwordx4 v[132:135], v9, s[40:43], 0 offen offset:1408
    buffer_load_dwordx4 v[136:139], v10, s[40:43], 0 offen offset:1408
    buffer_load_dwordx4 v[140:143], v11, s[40:43], 0 offen offset:1408
    ds_read_b128 v[152:155], v13 offset:32
    ds_read_b128 v[156:159], v14 offset:32
    s_waitcnt lgkmcnt(2)
    v_mfma_f32_32x32x16_bf16 v[160:175], v[144:147], v[148:151], v[160:175]
    ds_read_b128 v[144:147], v13 offset:64
    ds_read_b128 v[148:151], v14 offset:64
    s_waitcnt lgkmcnt(2)
    v_mfma_f32_32x32x16_bf16 v[160:175], v[152:155], v[156:159], v[160:175]
    ds_read_b128 v[152:155], v13 offset:96
    ds_read_b128 v[156:159], v14 offset:96
    s_waitcnt lgkmcnt(2)
    v_mfma_f32_32x32x16_bf16 v[160:175], v[144:147], v[148:151], v[160:175]
    ds_read_b128 v[144:147], v13 offset:18432
    ds_read_b128 v[148:151], v14 offset:18432
    s_waitcnt lgkmcnt(2)
    v_mfma_f32_32x32x16_bf16 v[160:175], v[152:155], v[156:159], v[160:175]
    s_barrier
    s_waitcnt vmcnt(20)
    ds_write_b128 v12, v[48:51] offset:0
    ds_write_b128 v12, v[52:55] offset:4608
    ds_write_b128 v12, v[56:59] offset:9216
    ds_write_b128 v12, v[60:63] offset:13824
    buffer_load_dwordx4 v[48:51], v8, s[40:43], 0 offen offset:1536
    buffer_load_dwordx4 v[52:55], v9, s[40:43], 0 offen offset:1536
    buffer_load_dwordx4 v[56:59], v10, s[40:43], 0 offen offset:1536
    buffer_load_dwordx4 v[60:63], v11, s[40:43], 0 offen offset:1536
    ds_read_b128 v[152:155], v13 offset:18464
    ds_read_b128 v[156:159], v14 offset:18464
    s_waitcnt lgkmcnt(2)
    v_mfma_f32_32x32x16_bf16 v[160:175], v[144:147], v[148:151], v[160:175]
    ds_read_b128 v[144:147], v13 offset:18496
    ds_read_b128 v[148:151], v14 offset:18496
    s_waitcnt lgkmcnt(2)
    v_mfma_f32_32x32x16_bf16 v[160:175], v[152:155], v[156:159], v[160:175]
    ds_read_b128 v[152:155], v13 offset:18528
    ds_read_b128 v[156:159], v14 offset:18528
    s_waitcnt lgkmcnt(2)
    v_mfma_f32_32x32x16_bf16 v[160:175], v[144:147], v[148:151], v[160:175]
    ds_read_b128 v[144:147], v13 offset:36864
    ds_read_b128 v[148:151], v14 offset:36864
    s_waitcnt lgkmcnt(2)
    v_mfma_f32_32x32x16_bf16 v[160:175], v[152:155], v[156:159], v[160:175]
    s_barrier
    s_waitcnt vmcnt(20)
    ds_write_b128 v12, v[64:67] offset:18432
    ds_write_b128 v12, v[68:71] offset:23040
    ds_write_b128 v12, v[72:75] offset:27648
    ds_write_b128 v12, v[76:79] offset:32256
    buffer_load_dwordx4 v[64:67], v8, s[40:43], 0 offen offset:1664
    buffer_load_dwordx4 v[68:71], v9, s[40:43], 0 offen offset:1664
    buffer_load_dwordx4 v[72:75], v10, s[40:43], 0 offen offset:1664
    buffer_load_dwordx4 v[76:79], v11, s[40:43], 0 offen offset:1664
    ds_read_b128 v[152:155], v13 offset:36896
    ds_read_b128 v[156:159], v14 offset:36896
    s_waitcnt lgkmcnt(2)
    v_mfma_f32_32x32x16_bf16 v[160:175], v[144:147], v[148:151], v[160:175]
    ds_read_b128 v[144:147], v13 offset:36928
    ds_read_b128 v[148:151], v14 offset:36928
    s_waitcnt lgkmcnt(2)
    v_mfma_f32_32x32x16_bf16 v[160:175], v[152:155], v[156:159], v[160:175]
    ds_read_b128 v[152:155], v13 offset:36960
    ds_read_b128 v[156:159], v14 offset:36960
    s_waitcnt lgkmcnt(2)
    v_mfma_f32_32x32x16_bf16 v[160:175], v[144:147], v[148:151], v[160:175]
    ds_read_b128 v[144:147], v13 offset:0
    ds_read_b128 v[148:151], v14 offset:0
    s_waitcnt lgkmcnt(2)
    v_mfma_f32_32x32x16_bf16 v[160:175], v[152:155], v[156:159], v[160:175]
    s_barrier
    s_waitcnt vmcnt(20)
    ds_write_b128 v12, v[80:83] offset:36864
    ds_write_b128 v12, v[84:87] offset:41472
    ds_write_b128 v12, v[88:91] offset:46080
    ds_write_b128 v12, v[92:95] offset:50688
    buffer_load_dwordx4 v[80:83], v8, s[40:43], 0 offen offset:1792
    buffer_load_dwordx4 v[84:87], v9, s[40:43], 0 offen offset:1792
    buffer_load_dwordx4 v[88:91], v10, s[40:43], 0 offen offset:1792
    buffer_load_dwordx4 v[92:95], v11, s[40:43], 0 offen offset:1792
    ds_read_b128 v[152:155], v13 offset:32
    ds_read_b128 v[156:159], v14 offset:32
    s_waitcnt lgkmcnt(2)
    v_mfma_f32_32x32x16_bf16 v[160:175], v[144:147], v[148:151], v[160:175]
    ds_read_b128 v[144:147], v13 offset:64
    ds_read_b128 v[148:151], v14 offset:64
    s_waitcnt lgkmcnt(2)
    v_mfma_f32_32x32x16_bf16 v[160:175], v[152:155], v[156:159], v[160:175]
    ds_read_b128 v[152:155], v13 offset:96
    ds_read_b128 v[156:159], v14 offset:96
    s_waitcnt lgkmcnt(2)
    v_mfma_f32_32x32x16_bf16 v[160:175], v[144:147], v[148:151], v[160:175]
    ds_read_b128 v[144:147], v13 offset:18432
    ds_read_b128 v[148:151], v14 offset:18432
    s_waitcnt lgkmcnt(2)
    v_mfma_f32_32x32x16_bf16 v[160:175], v[152:155], v[156:159], v[160:175]
    s_barrier
    s_waitcnt vmcnt(20)
    ds_write_b128 v12, v[96:99] offset:0
    ds_write_b128 v12, v[100:103] offset:4608
    ds_write_b128 v12, v[104:107] offset:9216
    ds_write_b128 v12, v[108:111] offset:13824
    buffer_load_dwordx4 v[96:99], v8, s[40:43], 0 offen offset:1920
    buffer_load_dwordx4 v[100:103], v9, s[40:43], 0 offen offset:1920
    buffer_load_dwordx4 v[104:107], v10, s[40:43], 0 offen offset:1920
    buffer_load_dwordx4 v[108:111], v11, s[40:43], 0 offen offset:1920
    ds_read_b128 v[152:155], v13 offset:18464
    ds_read_b128 v[156:159], v14 offset:18464
    s_waitcnt lgkmcnt(2)
    v_mfma_f32_32x32x16_bf16 v[160:175], v[144:147], v[148:151], v[160:175]
    ds_read_b128 v[144:147], v13 offset:18496
    ds_read_b128 v[148:151], v14 offset:18496
    s_waitcnt lgkmcnt(2)
    v_mfma_f32_32x32x16_bf16 v[160:175], v[152:155], v[156:159], v[160:175]
    ds_read_b128 v[152:155], v13 offset:18528
    ds_read_b128 v[156:159], v14 offset:18528
    s_waitcnt lgkmcnt(2)
    v_mfma_f32_32x32x16_bf16 v[160:175], v[144:147], v[148:151], v[160:175]
    ds_read_b128 v[144:147], v13 offset:36864
    ds_read_b128 v[148:151], v14 offset:36864
    s_waitcnt lgkmcnt(2)
    v_mfma_f32_32x32x16_bf16 v[160:175], v[152:155], v[156:159], v[160:175]
    s_barrier
    s_waitcnt vmcnt(20)
    ds_write_b128 v12, v[112:115] offset:18432
    ds_write_b128 v12, v[116:119] offset:23040
    ds_write_b128 v12, v[120:123] offset:27648
    ds_write_b128 v12, v[124:127] offset:32256
    buffer_load_dwordx4 v[112:115], v8, s[40:43], 0 offen offset:2048
    buffer_load_dwordx4 v[116:119], v9, s[40:43], 0 offen offset:2048
    buffer_load_dwordx4 v[120:123], v10, s[40:43], 0 offen offset:2048
    buffer_load_dwordx4 v[124:127], v11, s[40:43], 0 offen offset:2048
    ds_read_b128 v[152:155], v13 offset:36896
    ds_read_b128 v[156:159], v14 offset:36896
    s_waitcnt lgkmcnt(2)
    v_mfma_f32_32x32x16_bf16 v[160:175], v[144:147], v[148:151], v[160:175]
    ds_read_b128 v[144:147], v13 offset:36928
    ds_read_b128 v[148:151], v14 offset:36928
    s_waitcnt lgkmcnt(2)
    v_mfma_f32_32x32x16_bf16 v[160:175], v[152:155], v[156:159], v[160:175]
    ds_read_b128 v[152:155], v13 offset:36960
    ds_read_b128 v[156:159], v14 offset:36960
    s_waitcnt lgkmcnt(2)
    v_mfma_f32_32x32x16_bf16 v[160:175], v[144:147], v[148:151], v[160:175]
    ds_read_b128 v[144:147], v13 offset:0
    ds_read_b128 v[148:151], v14 offset:0
    s_waitcnt lgkmcnt(2)
    v_mfma_f32_32x32x16_bf16 v[160:175], v[152:155], v[156:159], v[160:175]
    s_barrier
    s_waitcnt vmcnt(20)
    ds_write_b128 v12, v[128:131] offset:36864
    ds_write_b128 v12, v[132:135] offset:41472
    ds_write_b128 v12, v[136:139] offset:46080
    ds_write_b128 v12, v[140:143] offset:50688
    buffer_load_dwordx4 v[128:131], v8, s[40:43], 0 offen offset:2176
    buffer_load_dwordx4 v[132:135], v9, s[40:43], 0 offen offset:2176
    buffer_load_dwordx4 v[136:139], v10, s[40:43], 0 offen offset:2176
    buffer_load_dwordx4 v[140:143], v11, s[40:43], 0 offen offset:2176
    ds_read_b128 v[152:155], v13 offset:32
    ds_read_b128 v[156:159], v14 offset:32
    s_waitcnt lgkmcnt(2)
    v_mfma_f32_32x32x16_bf16 v[160:175], v[144:147], v[148:151], v[160:175]
    ds_read_b128 v[144:147], v13 offset:64
    ds_read_b128 v[148:151], v14 offset:64
    s_waitcnt lgkmcnt(2)
    v_mfma_f32_32x32x16_bf16 v[160:175], v[152:155], v[156:159], v[160:175]
    ds_read_b128 v[152:155], v13 offset:96
    ds_read_b128 v[156:159], v14 offset:96
    s_waitcnt lgkmcnt(2)
    v_mfma_f32_32x32x16_bf16 v[160:175], v[144:147], v[148:151], v[160:175]
    ds_read_b128 v[144:147], v13 offset:18432
    ds_read_b128 v[148:151], v14 offset:18432
    s_waitcnt lgkmcnt(2)
    v_mfma_f32_32x32x16_bf16 v[160:175], v[152:155], v[156:159], v[160:175]
    s_barrier
    s_waitcnt vmcnt(20)
    ds_write_b128 v12, v[48:51] offset:0
    ds_write_b128 v12, v[52:55] offset:4608
    ds_write_b128 v12, v[56:59] offset:9216
    ds_write_b128 v12, v[60:63] offset:13824
    buffer_load_dwordx4 v[48:51], v8, s[40:43], 0 offen offset:2304
    buffer_load_dwordx4 v[52:55], v9, s[40:43], 0 offen offset:2304
    buffer_load_dwordx4 v[56:59], v10, s[40:43], 0 offen offset:2304
    buffer_load_dwordx4 v[60:63], v11, s[40:43], 0 offen offset:2304
    ds_read_b128 v[152:155], v13 offset:18464
    ds_read_b128 v[156:159], v14 offset:18464
    s_waitcnt lgkmcnt(2)
    v_mfma_f32_32x32x16_bf16 v[160:175], v[144:147], v[148:151], v[160:175]
    ds_read_b128 v[144:147], v13 offset:18496
    ds_read_b128 v[148:151], v14 offset:18496
    s_waitcnt lgkmcnt(2)
    v_mfma_f32_32x32x16_bf16 v[160:175], v[152:155], v[156:159], v[160:175]
    ds_read_b128 v[152:155], v13 offset:18528
    ds_read_b128 v[156:159], v14 offset:18528
    s_waitcnt lgkmcnt(2)
    v_mfma_f32_32x32x16_bf16 v[160:175], v[144:147], v[148:151], v[160:175]
    ds_read_b128 v[144:147], v13 offset:36864
    ds_read_b128 v[148:151], v14 offset:36864
    s_waitcnt lgkmcnt(2)
    v_mfma_f32_32x32x16_bf16 v[160:175], v[152:155], v[156:159], v[160:175]
    s_barrier
    s_waitcnt vmcnt(20)
    ds_write_b128 v12, v[64:67] offset:18432
    ds_write_b128 v12, v[68:71] offset:23040
    ds_write_b128 v12, v[72:75] offset:27648
    ds_write_b128 v12, v[76:79] offset:32256
    buffer_load_dwordx4 v[64:67], v8, s[40:43], 0 offen offset:2432
    buffer_load_dwordx4 v[68:71], v9, s[40:43], 0 offen offset:2432
    buffer_load_dwordx4 v[72:75], v10, s[40:43], 0 offen offset:2432
    buffer_load_dwordx4 v[76:79], v11, s[40:43], 0 offen offset:2432
    ds_read_b128 v[152:155], v13 offset:36896
    ds_read_b128 v[156:159], v14 offset:36896
    s_waitcnt lgkmcnt(2)
    v_mfma_f32_32x32x16_bf16 v[160:175], v[144:147], v[148:151], v[160:175]
    ds_read_b128 v[144:147], v13 offset:36928
    ds_read_b128 v[148:151], v14 offset:36928
    s_waitcnt lgkmcnt(2)
    v_mfma_f32_32x32x16_bf16 v[160:175], v[152:155], v[156:159], v[160:175]
    ds_read_b128 v[152:155], v13 offset:36960
    ds_read_b128 v[156:159], v14 offset:36960
    s_waitcnt lgkmcnt(2)
    v_mfma_f32_32x32x16_bf16 v[160:175], v[144:147], v[148:151], v[160:175]
    ds_read_b128 v[144:147], v13 offset:0
    ds_read_b128 v[148:151], v14 offset:0
    s_waitcnt lgkmcnt(2)
    v_mfma_f32_32x32x16_bf16 v[160:175], v[152:155], v[156:159], v[160:175]
    s_barrier
    s_waitcnt vmcnt(20)
    ds_write_b128 v12, v[80:83] offset:36864
    ds_write_b128 v12, v[84:87] offset:41472
    ds_write_b128 v12, v[88:91] offset:46080
    ds_write_b128 v12, v[92:95] offset:50688
    buffer_load_dwordx4 v[80:83], v8, s[40:43], 0 offen offset:2560
    buffer_load_dwordx4 v[84:87], v9, s[40:43], 0 offen offset:2560
    buffer_load_dwordx4 v[88:91], v10, s[40:43], 0 offen offset:2560
    buffer_load_dwordx4 v[92:95], v11, s[40:43], 0 offen offset:2560
    ds_read_b128 v[152:155], v13 offset:32
    ds_read_b128 v[156:159], v14 offset:32
    s_waitcnt lgkmcnt(2)
    v_mfma_f32_32x32x16_bf16 v[160:175], v[144:147], v[148:151], v[160:175]
    ds_read_b128 v[144:147], v13 offset:64
    ds_read_b128 v[148:151], v14 offset:64
    s_waitcnt lgkmcnt(2)
    v_mfma_f32_32x32x16_bf16 v[160:175], v[152:155], v[156:159], v[160:175]
    ds_read_b128 v[152:155], v13 offset:96
    ds_read_b128 v[156:159], v14 offset:96
    s_waitcnt lgkmcnt(2)
    v_mfma_f32_32x32x16_bf16 v[160:175], v[144:147], v[148:151], v[160:175]
    ds_read_b128 v[144:147], v13 offset:18432
    ds_read_b128 v[148:151], v14 offset:18432
    s_waitcnt lgkmcnt(2)
    v_mfma_f32_32x32x16_bf16 v[160:175], v[152:155], v[156:159], v[160:175]
    s_barrier
    s_waitcnt vmcnt(20)
    ds_write_b128 v12, v[96:99] offset:0
    ds_write_b128 v12, v[100:103] offset:4608
    ds_write_b128 v12, v[104:107] offset:9216
    ds_write_b128 v12, v[108:111] offset:13824
    buffer_load_dwordx4 v[96:99], v8, s[40:43], 0 offen offset:2688
    buffer_load_dwordx4 v[100:103], v9, s[40:43], 0 offen offset:2688
    buffer_load_dwordx4 v[104:107], v10, s[40:43], 0 offen offset:2688
    buffer_load_dwordx4 v[108:111], v11, s[40:43], 0 offen offset:2688
    ds_read_b128 v[152:155], v13 offset:18464
    ds_read_b128 v[156:159], v14 offset:18464
    s_waitcnt lgkmcnt(2)
    v_mfma_f32_32x32x16_bf16 v[160:175], v[144:147], v[148:151], v[160:175]
    ds_read_b128 v[144:147], v13 offset:18496
    ds_read_b128 v[148:151], v14 offset:18496
    s_waitcnt lgkmcnt(2)
    v_mfma_f32_32x32x16_bf16 v[160:175], v[152:155], v[156:159], v[160:175]
    ds_read_b128 v[152:155], v13 offset:18528
    ds_read_b128 v[156:159], v14 offset:18528
    s_waitcnt lgkmcnt(2)
    v_mfma_f32_32x32x16_bf16 v[160:175], v[144:147], v[148:151], v[160:175]
    ds_read_b128 v[144:147], v13 offset:36864
    ds_read_b128 v[148:151], v14 offset:36864
    s_waitcnt lgkmcnt(2)
    v_mfma_f32_32x32x16_bf16 v[160:175], v[152:155], v[156:159], v[160:175]
    s_barrier
    s_waitcnt vmcnt(20)
    ds_write_b128 v12, v[112:115] offset:18432
    ds_write_b128 v12, v[116:119] offset:23040
    ds_write_b128 v12, v[120:123] offset:27648
    ds_write_b128 v12, v[124:127] offset:32256
    ds_read_b128 v[152:155], v13 offset:36896
    ds_read_b128 v[156:159], v14 offset:36896
    s_waitcnt lgkmcnt(2)
    v_mfma_f32_32x32x16_bf16 v[160:175], v[144:147], v[148:151], v[160:175]
    ds_read_b128 v[144:147], v13 offset:36928
    ds_read_b128 v[148:151], v14 offset:36928
    s_waitcnt lgkmcnt(2)
    v_mfma_f32_32x32x16_bf16 v[160:175], v[152:155], v[156:159], v[160:175]
    ds_read_b128 v[152:155], v13 offset:36960
    ds_read_b128 v[156:159], v14 offset:36960
    s_waitcnt lgkmcnt(2)
    v_mfma_f32_32x32x16_bf16 v[160:175], v[144:147], v[148:151], v[160:175]
    ds_read_b128 v[144:147], v13 offset:0
    ds_read_b128 v[148:151], v14 offset:0
    s_waitcnt lgkmcnt(2)
    v_mfma_f32_32x32x16_bf16 v[160:175], v[152:155], v[156:159], v[160:175]
    s_barrier
    s_waitcnt vmcnt(16)
    ds_write_b128 v12, v[128:131] offset:36864
    ds_write_b128 v12, v[132:135] offset:41472
    ds_write_b128 v12, v[136:139] offset:46080
    ds_write_b128 v12, v[140:143] offset:50688
    ds_read_b128 v[152:155], v13 offset:32
    ds_read_b128 v[156:159], v14 offset:32
    s_waitcnt lgkmcnt(2)
    v_mfma_f32_32x32x16_bf16 v[160:175], v[144:147], v[148:151], v[160:175]
    ds_read_b128 v[144:147], v13 offset:64
    ds_read_b128 v[148:151], v14 offset:64
    s_waitcnt lgkmcnt(2)
    v_mfma_f32_32x32x16_bf16 v[160:175], v[152:155], v[156:159], v[160:175]
    ds_read_b128 v[152:155], v13 offset:96
    ds_read_b128 v[156:159], v14 offset:96
    s_waitcnt lgkmcnt(2)
    v_mfma_f32_32x32x16_bf16 v[160:175], v[144:147], v[148:151], v[160:175]
    ds_read_b128 v[144:147], v13 offset:18432
    ds_read_b128 v[148:151], v14 offset:18432
    s_waitcnt lgkmcnt(2)
    v_mfma_f32_32x32x16_bf16 v[160:175], v[152:155], v[156:159], v[160:175]
    s_barrier
    s_waitcnt vmcnt(12)
    ds_write_b128 v12, v[48:51] offset:0
    ds_write_b128 v12, v[52:55] offset:4608
    ds_write_b128 v12, v[56:59] offset:9216
    ds_write_b128 v12, v[60:63] offset:13824
    ds_read_b128 v[152:155], v13 offset:18464
    ds_read_b128 v[156:159], v14 offset:18464
    s_waitcnt lgkmcnt(2)
    v_mfma_f32_32x32x16_bf16 v[160:175], v[144:147], v[148:151], v[160:175]
    ds_read_b128 v[144:147], v13 offset:18496
    ds_read_b128 v[148:151], v14 offset:18496
    s_waitcnt lgkmcnt(2)
    v_mfma_f32_32x32x16_bf16 v[160:175], v[152:155], v[156:159], v[160:175]
    ds_read_b128 v[152:155], v13 offset:18528
    ds_read_b128 v[156:159], v14 offset:18528
    s_waitcnt lgkmcnt(2)
    v_mfma_f32_32x32x16_bf16 v[160:175], v[144:147], v[148:151], v[160:175]
    ds_read_b128 v[144:147], v13 offset:36864
    ds_read_b128 v[148:151], v14 offset:36864
    s_waitcnt lgkmcnt(2)
    v_mfma_f32_32x32x16_bf16 v[160:175], v[152:155], v[156:159], v[160:175]
    s_barrier
    s_waitcnt vmcnt(8)
    ds_write_b128 v12, v[64:67] offset:18432
    ds_write_b128 v12, v[68:71] offset:23040
    ds_write_b128 v12, v[72:75] offset:27648
    ds_write_b128 v12, v[76:79] offset:32256
    ds_read_b128 v[152:155], v13 offset:36896
    ds_read_b128 v[156:159], v14 offset:36896
    s_waitcnt lgkmcnt(2)
    v_mfma_f32_32x32x16_bf16 v[160:175], v[144:147], v[148:151], v[160:175]
    ds_read_b128 v[144:147], v13 offset:36928
    ds_read_b128 v[148:151], v14 offset:36928
    s_waitcnt lgkmcnt(2)
    v_mfma_f32_32x32x16_bf16 v[160:175], v[152:155], v[156:159], v[160:175]
    ds_read_b128 v[152:155], v13 offset:36960
    ds_read_b128 v[156:159], v14 offset:36960
    s_waitcnt lgkmcnt(2)
    v_mfma_f32_32x32x16_bf16 v[160:175], v[144:147], v[148:151], v[160:175]
    ds_read_b128 v[144:147], v13 offset:0
    ds_read_b128 v[148:151], v14 offset:0
    s_waitcnt lgkmcnt(2)
    v_mfma_f32_32x32x16_bf16 v[160:175], v[152:155], v[156:159], v[160:175]
    s_barrier
    s_waitcnt vmcnt(4)
    ds_write_b128 v12, v[80:83] offset:36864
    ds_write_b128 v12, v[84:87] offset:41472
    ds_write_b128 v12, v[88:91] offset:46080
    ds_write_b128 v12, v[92:95] offset:50688
    ds_read_b128 v[152:155], v13 offset:32
    ds_read_b128 v[156:159], v14 offset:32
    s_waitcnt lgkmcnt(2)
    v_mfma_f32_32x32x16_bf16 v[160:175], v[144:147], v[148:151], v[160:175]
    ds_read_b128 v[144:147], v13 offset:64
    ds_read_b128 v[148:151], v14 offset:64
    s_waitcnt lgkmcnt(2)
    v_mfma_f32_32x32x16_bf16 v[160:175], v[152:155], v[156:159], v[160:175]
    ds_read_b128 v[152:155], v13 offset:96
    ds_read_b128 v[156:159], v14 offset:96
    s_waitcnt lgkmcnt(2)
    v_mfma_f32_32x32x16_bf16 v[160:175], v[144:147], v[148:151], v[160:175]
    ds_read_b128 v[144:147], v13 offset:18432
    ds_read_b128 v[148:151], v14 offset:18432
    s_waitcnt lgkmcnt(2)
    v_mfma_f32_32x32x16_bf16 v[160:175], v[152:155], v[156:159], v[160:175]
    s_barrier
    s_waitcnt vmcnt(0)
    ds_write_b128 v12, v[96:99] offset:0
    ds_write_b128 v12, v[100:103] offset:4608
    ds_write_b128 v12, v[104:107] offset:9216
    ds_write_b128 v12, v[108:111] offset:13824
    ds_read_b128 v[152:155], v13 offset:18464
    ds_read_b128 v[156:159], v14 offset:18464
    s_waitcnt lgkmcnt(2)
    v_mfma_f32_32x32x16_bf16 v[160:175], v[144:147], v[148:151], v[160:175]
    ds_read_b128 v[144:147], v13 offset:18496
    ds_read_b128 v[148:151], v14 offset:18496
    s_waitcnt lgkmcnt(2)
    v_mfma_f32_32x32x16_bf16 v[160:175], v[152:155], v[156:159], v[160:175]
    ds_read_b128 v[152:155], v13 offset:18528
    ds_read_b128 v[156:159], v14 offset:18528
    s_waitcnt lgkmcnt(2)
    v_mfma_f32_32x32x16_bf16 v[160:175], v[144:147], v[148:151], v[160:175]
    ds_read_b128 v[144:147], v13 offset:36864
    ds_read_b128 v[148:151], v14 offset:36864
    s_waitcnt lgkmcnt(2)
    v_mfma_f32_32x32x16_bf16 v[160:175], v[152:155], v[156:159], v[160:175]
    s_barrier
    ds_read_b128 v[152:155], v13 offset:36896
    ds_read_b128 v[156:159], v14 offset:36896
    s_waitcnt lgkmcnt(2)
    v_mfma_f32_32x32x16_bf16 v[160:175], v[144:147], v[148:151], v[160:175]
    ds_read_b128 v[144:147], v13 offset:36928
    ds_read_b128 v[148:151], v14 offset:36928
    s_waitcnt lgkmcnt(2)
    v_mfma_f32_32x32x16_bf16 v[160:175], v[152:155], v[156:159], v[160:175]
    ds_read_b128 v[152:155], v13 offset:36960
    ds_read_b128 v[156:159], v14 offset:36960
    s_waitcnt lgkmcnt(2)
    v_mfma_f32_32x32x16_bf16 v[160:175], v[144:147], v[148:151], v[160:175]
    ds_read_b128 v[144:147], v13 offset:0
    ds_read_b128 v[148:151], v14 offset:0
    s_waitcnt lgkmcnt(2)
    v_mfma_f32_32x32x16_bf16 v[160:175], v[152:155], v[156:159], v[160:175]
    s_barrier
    ds_read_b128 v[152:155], v13 offset:32
    ds_read_b128 v[156:159], v14 offset:32
    s_waitcnt lgkmcnt(2)
    v_mfma_f32_32x32x16_bf16 v[160:175], v[144:147], v[148:151], v[160:175]
    ds_read_b128 v[144:147], v13 offset:64
    ds_read_b128 v[148:151], v14 offset:64
    s_waitcnt lgkmcnt(2)
    v_mfma_f32_32x32x16_bf16 v[160:175], v[152:155], v[156:159], v[160:175]
    ds_read_b128 v[152:155], v13 offset:96
    ds_read_b128 v[156:159], v14 offset:96
    s_waitcnt lgkmcnt(2)
    v_mfma_f32_32x32x16_bf16 v[160:175], v[144:147], v[148:151], v[160:175]
    s_waitcnt lgkmcnt(0)
    v_mfma_f32_32x32x16_bf16 v[160:175], v[152:155], v[156:159], v[160:175]
    s_nop 7
    s_nop 7
    v_mov_b32 v46, v44
    v_mov_b32 v47, v44
    v_sub_f32 v48, 1.0, v44
    v_cvt_pk_bf16_f32 v50, v48, v48
    v_lshlrev_b32 v48, 16, v50
    v_mov_b32 v49, v48
    v_lshlrev_b32 v52, 16, v20
    v_lshlrev_b32 v53, 16, v21
    v_lshlrev_b32 v54, 16, v36
    v_and_b32 v55, 0xffff0000, v36
    v_pk_mul_f32 v[52:53], v[54:55], v[52:53]
    v_cvt_pk_bf16_f32 v56, v52, v53
    v_lshlrev_b32 v52, 16, v56
    v_and_b32 v53, 0xffff0000, v56
    v_pk_mul_f32 v[52:53], v[46:47], v[52:53]
    v_cvt_pk_bf16_f32 v56, v52, v53
    v_lshlrev_b32 v52, 16, v56
    v_and_b32 v53, 0xffff0000, v56
    v_cvt_pk_bf16_f32 v56, v160, v161
    v_lshlrev_b32 v160, 16, v56
    v_and_b32 v161, 0xffff0000, v56
    v_pk_mul_f32 v[160:161], v[48:49], v[160:161]
    v_cvt_pk_bf16_f32 v56, v160, v161
    v_lshlrev_b32 v160, 16, v56
    v_and_b32 v161, 0xffff0000, v56
    v_pk_add_f32 v[160:161], v[160:161], v[52:53]
    v_cvt_pk_bf16_f32 v58, v160, v161
    v_lshlrev_b32 v52, 16, v22
    v_lshlrev_b32 v53, 16, v23
    v_lshlrev_b32 v54, 16, v37
    v_and_b32 v55, 0xffff0000, v37
    v_pk_mul_f32 v[52:53], v[54:55], v[52:53]
    v_cvt_pk_bf16_f32 v56, v52, v53
    v_lshlrev_b32 v52, 16, v56
    v_and_b32 v53, 0xffff0000, v56
    v_pk_mul_f32 v[52:53], v[46:47], v[52:53]
    v_cvt_pk_bf16_f32 v56, v52, v53
    v_lshlrev_b32 v52, 16, v56
    v_and_b32 v53, 0xffff0000, v56
    v_cvt_pk_bf16_f32 v56, v162, v163
    v_lshlrev_b32 v162, 16, v56
    v_and_b32 v163, 0xffff0000, v56
    v_pk_mul_f32 v[162:163], v[48:49], v[162:163]
    v_cvt_pk_bf16_f32 v56, v162, v163
    v_lshlrev_b32 v162, 16, v56
    v_and_b32 v163, 0xffff0000, v56
    v_pk_add_f32 v[162:163], v[162:163], v[52:53]
    v_cvt_pk_bf16_f32 v59, v162, v163
    buffer_store_dwordx2 v[58:59], v15, s[32:35], 0 offen offset:0
    s_nop 0
    v_lshlrev_b32 v52, 16, v24
    v_lshlrev_b32 v53, 16, v25
    v_lshlrev_b32 v54, 16, v38
    v_and_b32 v55, 0xffff0000, v38
    v_pk_mul_f32 v[52:53], v[54:55], v[52:53]
    v_cvt_pk_bf16_f32 v56, v52, v53
    v_lshlrev_b32 v52, 16, v56
    v_and_b32 v53, 0xffff0000, v56
    v_pk_mul_f32 v[52:53], v[46:47], v[52:53]
    v_cvt_pk_bf16_f32 v56, v52, v53
    v_lshlrev_b32 v52, 16, v56
    v_and_b32 v53, 0xffff0000, v56
    v_cvt_pk_bf16_f32 v56, v164, v165
    v_lshlrev_b32 v164, 16, v56
    v_and_b32 v165, 0xffff0000, v56
    v_pk_mul_f32 v[164:165], v[48:49], v[164:165]
    v_cvt_pk_bf16_f32 v56, v164, v165
    v_lshlrev_b32 v164, 16, v56
    v_and_b32 v165, 0xffff0000, v56
    v_pk_add_f32 v[164:165], v[164:165], v[52:53]
    v_cvt_pk_bf16_f32 v58, v164, v165
    v_lshlrev_b32 v52, 16, v26
    v_lshlrev_b32 v53, 16, v27
    v_lshlrev_b32 v54, 16, v39
    v_and_b32 v55, 0xffff0000, v39
    v_pk_mul_f32 v[52:53], v[54:55], v[52:53]
    v_cvt_pk_bf16_f32 v56, v52, v53
    v_lshlrev_b32 v52, 16, v56
    v_and_b32 v53, 0xffff0000, v56
    v_pk_mul_f32 v[52:53], v[46:47], v[52:53]
    v_cvt_pk_bf16_f32 v56, v52, v53
    v_lshlrev_b32 v52, 16, v56
    v_and_b32 v53, 0xffff0000, v56
    v_cvt_pk_bf16_f32 v56, v166, v167
    v_lshlrev_b32 v166, 16, v56
    v_and_b32 v167, 0xffff0000, v56
    v_pk_mul_f32 v[166:167], v[48:49], v[166:167]
    v_cvt_pk_bf16_f32 v56, v166, v167
    v_lshlrev_b32 v166, 16, v56
    v_and_b32 v167, 0xffff0000, v56
    v_pk_add_f32 v[166:167], v[166:167], v[52:53]
    v_cvt_pk_bf16_f32 v59, v166, v167
    buffer_store_dwordx2 v[58:59], v15, s[32:35], 0 offen offset:16
    s_nop 0
    v_lshlrev_b32 v52, 16, v28
    v_lshlrev_b32 v53, 16, v29
    v_lshlrev_b32 v54, 16, v40
    v_and_b32 v55, 0xffff0000, v40
    v_pk_mul_f32 v[52:53], v[54:55], v[52:53]
    v_cvt_pk_bf16_f32 v56, v52, v53
    v_lshlrev_b32 v52, 16, v56
    v_and_b32 v53, 0xffff0000, v56
    v_pk_mul_f32 v[52:53], v[46:47], v[52:53]
    v_cvt_pk_bf16_f32 v56, v52, v53
    v_lshlrev_b32 v52, 16, v56
    v_and_b32 v53, 0xffff0000, v56
    v_cvt_pk_bf16_f32 v56, v168, v169
    v_lshlrev_b32 v168, 16, v56
    v_and_b32 v169, 0xffff0000, v56
    v_pk_mul_f32 v[168:169], v[48:49], v[168:169]
    v_cvt_pk_bf16_f32 v56, v168, v169
    v_lshlrev_b32 v168, 16, v56
    v_and_b32 v169, 0xffff0000, v56
    v_pk_add_f32 v[168:169], v[168:169], v[52:53]
    v_cvt_pk_bf16_f32 v58, v168, v169
    v_lshlrev_b32 v52, 16, v30
    v_lshlrev_b32 v53, 16, v31
    v_lshlrev_b32 v54, 16, v41
    v_and_b32 v55, 0xffff0000, v41
    v_pk_mul_f32 v[52:53], v[54:55], v[52:53]
    v_cvt_pk_bf16_f32 v56, v52, v53
    v_lshlrev_b32 v52, 16, v56
    v_and_b32 v53, 0xffff0000, v56
    v_pk_mul_f32 v[52:53], v[46:47], v[52:53]
    v_cvt_pk_bf16_f32 v56, v52, v53
    v_lshlrev_b32 v52, 16, v56
    v_and_b32 v53, 0xffff0000, v56
    v_cvt_pk_bf16_f32 v56, v170, v171
    v_lshlrev_b32 v170, 16, v56
    v_and_b32 v171, 0xffff0000, v56
    v_pk_mul_f32 v[170:171], v[48:49], v[170:171]
    v_cvt_pk_bf16_f32 v56, v170, v171
    v_lshlrev_b32 v170, 16, v56
    v_and_b32 v171, 0xffff0000, v56
    v_pk_add_f32 v[170:171], v[170:171], v[52:53]
    v_cvt_pk_bf16_f32 v59, v170, v171
    buffer_store_dwordx2 v[58:59], v15, s[32:35], 0 offen offset:32
    s_nop 0
    v_lshlrev_b32 v52, 16, v32
    v_lshlrev_b32 v53, 16, v33
    v_lshlrev_b32 v54, 16, v42
    v_and_b32 v55, 0xffff0000, v42
    v_pk_mul_f32 v[52:53], v[54:55], v[52:53]
    v_cvt_pk_bf16_f32 v56, v52, v53
    v_lshlrev_b32 v52, 16, v56
    v_and_b32 v53, 0xffff0000, v56
    v_pk_mul_f32 v[52:53], v[46:47], v[52:53]
    v_cvt_pk_bf16_f32 v56, v52, v53
    v_lshlrev_b32 v52, 16, v56
    v_and_b32 v53, 0xffff0000, v56
    v_cvt_pk_bf16_f32 v56, v172, v173
    v_lshlrev_b32 v172, 16, v56
    v_and_b32 v173, 0xffff0000, v56
    v_pk_mul_f32 v[172:173], v[48:49], v[172:173]
    v_cvt_pk_bf16_f32 v56, v172, v173
    v_lshlrev_b32 v172, 16, v56
    v_and_b32 v173, 0xffff0000, v56
    v_pk_add_f32 v[172:173], v[172:173], v[52:53]
    v_cvt_pk_bf16_f32 v58, v172, v173
    v_lshlrev_b32 v52, 16, v34
    v_lshlrev_b32 v53, 16, v35
    v_lshlrev_b32 v54, 16, v43
    v_and_b32 v55, 0xffff0000, v43
    v_pk_mul_f32 v[52:53], v[54:55], v[52:53]
    v_cvt_pk_bf16_f32 v56, v52, v53
    v_lshlrev_b32 v52, 16, v56
    v_and_b32 v53, 0xffff0000, v56
    v_pk_mul_f32 v[52:53], v[46:47], v[52:53]
    v_cvt_pk_bf16_f32 v56, v52, v53
    v_lshlrev_b32 v52, 16, v56
    v_and_b32 v53, 0xffff0000, v56
    v_cvt_pk_bf16_f32 v56, v174, v175
    v_lshlrev_b32 v174, 16, v56
    v_and_b32 v175, 0xffff0000, v56
    v_pk_mul_f32 v[174:175], v[48:49], v[174:175]
    v_cvt_pk_bf16_f32 v56, v174, v175
    v_lshlrev_b32 v174, 16, v56
    v_and_b32 v175, 0xffff0000, v56
    v_pk_add_f32 v[174:175], v[174:175], v[52:53]
    v_cvt_pk_bf16_f32 v59, v174, v175
    buffer_store_dwordx2 v[58:59], v15, s[32:35], 0 offen offset:48
    s_nop 0
L_k2_done:
    s_endpgm
.section .rodata,"a"
.p2align 6
.amdhsa_kernel conv_gemm1_kernel
  .amdhsa_next_free_vgpr 208
  .amdhsa_next_free_sgpr 96
  .amdhsa_accum_offset 208
  .amdhsa_group_segment_fixed_size 0
  .amdhsa_kernarg_size 112
  .amdhsa_user_sgpr_count 2
  .amdhsa_user_sgpr_kernarg_segment_ptr 1
  .amdhsa_system_sgpr_workgroup_id_x 1
  .amdhsa_float_denorm_mode_32 3
  .amdhsa_float_denorm_mode_16_64 3
.end_amdhsa_kernel
.p2align 6
.amdhsa_kernel gemm2_kernel
  .amdhsa_next_free_vgpr 184
  .amdhsa_next_free_sgpr 96
  .amdhsa_accum_offset 184
  .amdhsa_group_segment_fixed_size 0
  .amdhsa_kernarg_size 112
  .amdhsa_user_sgpr_count 2
  .amdhsa_user_sgpr_kernarg_segment_ptr 1
  .amdhsa_system_sgpr_workgroup_id_x 1
  .amdhsa_float_denorm_mode_32 3
  .amdhsa_float_denorm_mode_16_64 3
.end_amdhsa_kernel
```
